```python
import torch

def _softmax(x, axis=-1):
    return torch.softmax(x, dim=axis)
def _gelu(x):
    return torch.nn.functional.gelu(x, approximate="tanh")
def _silu(x):
    return torch.nn.functional.silu(x)
def _sigmoid(x):
    return torch.sigmoid(x)
def _layernorm(x, axis=-1, eps=1e-5):
    m = x.mean(dim=axis, keepdim=True)
    v = x.var(dim=axis, keepdim=True, unbiased=False)
    return (x - m) / torch.sqrt(v + eps)
def _scatter_add(tgt, idx, src, axis=0):
    return tgt.clone().index_add_(axis, idx, src)
def _segment_sum(src, seg, n):
    out = torch.zeros((n,) + src.shape[1:], dtype=src.dtype)
    return out.index_add_(0, seg, src)
def _pad(x, pw):
    flat = tuple(v for pair in reversed(pw) for v in pair)
    return torch.nn.functional.pad(x, flat)

kernel_name = 'concat_heads__ssm_conv_s4__mha_block__prompt'

def setup_inputs():

    _w = (lambda a: (lambda t: t.to(torch.bfloat16) if t.is_floating_point() else t)(torch.as_tensor(a)))
    def _A_setup():
        B, L, D, N = 1, 2048, 576, 128
        A_re = -(lambda _x: torch.exp(torch.as_tensor(_x)))((lambda *s: torch.randn(*s, dtype=torch.bfloat16) * 6.4)(D, N))
        A_im = torch.pi * (lambda *s: torch.randn(*s, dtype=torch.bfloat16) * 0.1)(D, N)
        B_re = (lambda *s: torch.randn(*s, dtype=torch.bfloat16) * 0.2)(D, N)
        B_im = (lambda *s: torch.randn(*s, dtype=torch.bfloat16) * 0.2)(D, N)
        C_re = (lambda *s: torch.randn(*s, dtype=torch.bfloat16) * 0.2)(D, N)
        C_im = (lambda *s: torch.randn(*s, dtype=torch.bfloat16) * 0.2)(D, N)
        log_dt = (lambda *s: torch.randn(*s, dtype=torch.bfloat16) * 0.1)(D) * 0.5 - 4.0
        Dskip = (lambda *s: torch.randn(*s, dtype=torch.bfloat16) * 0.1)(D)
        return {
            "u": _w((lambda *s: torch.randn(*s, dtype=torch.bfloat16) * 0.05)(B, L, D)),
            "A_re": _w(A_re),
            "A_im": _w(A_im),
            "B_re": _w(B_re),
            "B_im": _w(B_im),
            "C_re": _w(C_re),
            "C_im": _w(C_im),
            "log_dt": _w(log_dt),
            "Dskip": _w(Dskip),
        }
    _A_in = _A_setup()

    def _B_setup():
        B, S, D, H = 1, 2048, 576, 32
        return {
            "x": _w((lambda *s: torch.randn(*s, dtype=torch.bfloat16) * 0.2)(B, S, D)),
            "wqkv": _w((lambda *s: torch.randn(*s, dtype=torch.bfloat16) * 0.2)(D, 3 * D)),
            "wo": _w((lambda *s: torch.randn(*s, dtype=torch.bfloat16) * 0.05)(D, D)),
        }
    _B_in = _B_setup()

    return {
        "A_u": _A_in["u"],
        "A_A_re": _A_in["A_re"],
        "A_A_im": _A_in["A_im"],
        "A_B_re": _A_in["B_re"],
        "A_B_im": _A_in["B_im"],
        "A_C_re": _A_in["C_re"],
        "A_C_im": _A_in["C_im"],
        "A_log_dt": _A_in["log_dt"],
        "A_Dskip": _A_in["Dskip"],
        "B_x": _B_in["x"],
        "B_wqkv": _B_in["wqkv"],
        "B_wo": _B_in["wo"],
    }

def reference(A_u, A_A_re, A_A_im, A_B_re, A_B_im, A_C_re, A_C_im, A_log_dt, A_Dskip, B_x, B_wqkv, B_wo):
    def _A_ref(u, A_re, A_im, B_re, B_im, C_re, C_im, log_dt, Dskip):
        Bsz, L, D = u.shape
        dt = torch.exp(log_dt)[:, None]
        A = A_re + 1j * A_im
        Bc = B_re + 1j * B_im
        Cc = C_re + 1j * C_im
        logdA = dt * A
        dB = dt * Bc
        l = (lambda x, dt: x.to(dt))(torch.arange(L), A_re.dtype)
        P = torch.exp(logdA[:, :, None] * l[None, None, :])
        K = torch.einsum("dn,dnl,dn->dl", Cc, P, dB).real
        L2 = 2 * L
        Kp = _pad(K, ((0, 0), (0, L)))
        up = (lambda x, *d: x.permute(*d))(u, 0, 2, 1)
        up = _pad(up, ((0, 0), (0, 0), (0, L)))
        Kf = (lambda x, axes=(-2,-1): torch.fft.rfft2(x.float(), dim=axes))(Kp[:, None, :], axes=(-2, -1))
        Uf = (lambda x, axes=(-2,-1): torch.fft.rfft2(x.float(), dim=axes))(up[:, :, None, :], axes=(-2, -1))
        Yf = Uf * Kf[None, :, :, :]
        y = (lambda x, s, axes=(-2,-1): torch.fft.irfft2(x, s=s, dim=axes).to(torch.bfloat16))(Yf, (1, L2), axes=(-2, -1))[:, :, 0, :L]
        y = (lambda x, *d: x.permute(*d))(y, 0, 2, 1) + u * Dskip[None, None, :]
        return y

    def _B_ref(x, wqkv, wo):
        B, S, D = x.shape
        H = 32
        Dh = D // H
        qkv = (lambda x, *d: x.permute(*d))((x @ wqkv).reshape(B, S, 3, H, Dh), 2, 0, 3, 1, 4)
        q, k, v = qkv[0], qkv[1], qkv[2]
        scores = torch.einsum("bhqd,bhkd->bhqk", q, k) * (Dh ** -0.5)
        p = _softmax(scores, axis=-1)
        o = torch.einsum("bhqk,bhkd->bhqd", p, v)
        return (lambda x, *d: x.permute(*d))(o, 0, 2, 1, 3).reshape(B, S, D) @ wo

    a = _A_ref(A_u, A_A_re, A_A_im, A_B_re, A_B_im, A_C_re, A_C_im, A_log_dt, A_Dskip)
    b = _B_ref(B_x, B_wqkv, B_wo)
    return torch.concatenate([a, b], axis=-1)
```

```asm
; @launch grid=(256,1,1) block=(512,1,1) lds=163840
.amdgcn_target "amdgcn-amd-amdhsa--gfx950"
.text
.globl concat_heads__ssm_conv_s4__mha_block__prompt_kernel
.p2align 8
.type concat_heads__ssm_conv_s4__mha_block__prompt_kernel,@function
concat_heads__ssm_conv_s4__mha_block__prompt_kernel:
    s_cmp_ge_u32 s2, 256
    s_cbranch_scc1 L_end
    s_load_dwordx2 s[4:5], s[0:1], 0
    s_load_dwordx16 s[32:47], s[0:1], 8
    s_load_dwordx8 s[52:59], s[0:1], 72
    s_load_dwordx4 s[48:51], s[0:1], 104
    s_cmp_ge_u32 s2, 24
    s_cbranch_scc1 L_pf_1
    v_cmp_gt_u32 vcc, 128, v0
    s_getpc_b64 s[96:97]
L_pc_2:
    s_sub_u32 s96, s96, L_pc_2-concat_heads__ssm_conv_s4__mha_block__prompt_kernel
    s_subb_u32 s97, s97, 0
    s_cbranch_vccz L_pf_1
    s_lshr_b32 s98, s2, 3
    s_mul_i32 s98, s98, 16384
    v_lshl_add_u32 v248, v0, 7, s98
    v_min_u32 v248, L_end-concat_heads__ssm_conv_s4__mha_block__prompt_kernel, v248
    global_load_dword v249, v248, s[96:97]
L_pf_1:
    v_lshrrev_b32 v2, 6, v0
    v_and_b32 v1, 63, v0
    s_and_b32 s60, s2, 7
    v_readfirstlane_b32 s3, v2
    s_lshr_b32 s61, s2, 3
    s_mov_b32 s10, 2359296
    s_mov_b32 s11, 0x00020000
    s_mov_b32 s14, 1990656
    s_mov_b32 s15, 0x00020000
    s_mov_b32 s18, 15798272
    s_mov_b32 s19, 0x00020000
    s_mov_b32 s22, 4718592
    s_mov_b32 s23, 0x00020000
    s_mov_b32 s26, 2359296
    s_mov_b32 s27, 0x00020000
    s_mov_b32 s30, 663552
    s_mov_b32 s31, 0x00020000
    s_waitcnt lgkmcnt(0)
    s_mov_b32 s24, s4
    s_mov_b32 s25, s5
    s_mov_b32 s8, s52
    s_mov_b32 s9, s53
    s_mov_b32 s12, s54
    s_mov_b32 s13, s55
    s_mov_b32 s28, s56
    s_mov_b32 s29, s57
    s_mov_b32 s20, s58
    s_mov_b32 s21, s59
    s_mov_b32 s16, s50
    s_mov_b32 s17, s51
    s_cmp_ge_u32 s61, 24
    s_cbranch_scc1 L_ssm_3
    s_and_b32 s62, s60, 3
    s_lshl_b32 s62, s62, 2
    s_and_b32 s64, s61, 3
    s_add_u32 s62, s62, s64
    s_lshr_b32 s63, s60, 2
    s_mul_i32 s63, s63, 6
    s_lshr_b32 s64, s61, 2
    s_add_u32 s63, s63, s64
    s_and_b32 s64, s3, 6
    s_cmp_lg_u32 s64, 4
    s_cbranch_scc1 L_nold_13
    v_lshrrev_b32 v9, 3, v1
    v_and_b32 v10, 7, v1
    v_lshrrev_b32 v11, 1, v9
    v_xor_b32 v10, v10, v11
    v_mul_u32_u24 v9, 1152, v9
    v_lshl_add_u32 v2, v10, 4, v9
    v_xor_b32 v10, 4, v10
    v_lshl_add_u32 v3, v10, 4, v9
    v_add_u32 v3, 9216, v3
    s_add_u32 s66, s62, s63
    s_mul_i32 s69, s66, 86
    s_lshr_b32 s69, s69, 8
    s_mul_i32 s69, s69, 3
    s_sub_u32 s66, s66, s69
    s_mul_i32 s66, s66, 3
    s_lshr_b32 s66, s66, 0
    s_and_b32 s70, s3, 1
    s_lshl_b32 s64, s62, 1
    s_add_u32 s64, s64, s70
    s_mul_i32 s64, s64, 73728
    s_lshl_b32 s69, s66, 7
    s_add_u32 s64, s64, s69
    s_lshl_b32 s67, s70, 13
    s_mul_i32 s68, s70, 10240
    s_add_u32 s68, s68, 49152
    s_lshl_b32 s69, s66, 1
    s_add_u32 s69, s69, s70
    s_mul_i32 s69, s69, 110592
    s_mul_i32 s65, s63, 288
    s_add_u32 s65, s65, s69
    s_add_u32 m0, s67, 0
    s_add_u32 s71, s64, 0
    buffer_load_dwordx4 v2, s[8:11], s71 offen lds
    s_add_u32 m0, s67, 1024
    s_add_u32 s71, s64, 0
    buffer_load_dwordx4 v3, s[8:11], s71 offen lds
    s_add_u32 m0, s67, 2048
    s_add_u32 s71, s64, 18432
    buffer_load_dwordx4 v2, s[8:11], s71 offen lds
    s_add_u32 m0, s67, 3072
    s_add_u32 s71, s64, 18432
    buffer_load_dwordx4 v3, s[8:11], s71 offen lds
    s_add_u32 m0, s67, 4096
    s_add_u32 s71, s64, 36864
    buffer_load_dwordx4 v2, s[8:11], s71 offen lds
    s_add_u32 m0, s67, 5120
    s_add_u32 s71, s64, 36864
    buffer_load_dwordx4 v3, s[8:11], s71 offen lds
    s_add_u32 m0, s67, 6144
    s_add_u32 s71, s64, 55296
    buffer_load_dwordx4 v2, s[8:11], s71 offen lds
    s_add_u32 m0, s67, 7168
    s_add_u32 s71, s64, 55296
    buffer_load_dwordx4 v3, s[8:11], s71 offen lds
    v_add_u32 v9, 0, v1
    v_mul_u32_u24 v10, 205, v9
    v_lshrrev_b32 v10, 12, v10
    v_mul_u32_u24 v11, 20, v10
    v_sub_u32 v9, v9, v11
    v_subrev_u32 v11, 2, v9
    v_max_u32 v11, 16, v11
    v_min_u32 v9, v9, v11
    v_mul_u32_u24 v10, 3456, v10
    v_lshl_add_u32 v4, v9, 4, v10
    s_add_u32 m0, s68, 0
    s_add_u32 s71, s65, 0
    buffer_load_dwordx4 v4, s[12:15], s71 offen lds
    s_add_u32 m0, s68, 5120
    s_add_u32 s71, s65, 55296
    buffer_load_dwordx4 v4, s[12:15], s71 offen lds
    v_add_u32 v9, 64, v1
    v_mul_u32_u24 v10, 205, v9
    v_lshrrev_b32 v10, 12, v10
    v_mul_u32_u24 v11, 20, v10
    v_sub_u32 v9, v9, v11
    v_subrev_u32 v11, 2, v9
    v_max_u32 v11, 16, v11
    v_min_u32 v9, v9, v11
    v_mul_u32_u24 v10, 3456, v10
    v_lshl_add_u32 v5, v9, 4, v10
    s_add_u32 m0, s68, 1024
    s_add_u32 s71, s65, 0
    buffer_load_dwordx4 v5, s[12:15], s71 offen lds
    s_add_u32 m0, s68, 6144
    s_add_u32 s71, s65, 55296
    buffer_load_dwordx4 v5, s[12:15], s71 offen lds
    v_add_u32 v9, 128, v1
    v_mul_u32_u24 v10, 205, v9
    v_lshrrev_b32 v10, 12, v10
    v_mul_u32_u24 v11, 20, v10
    v_sub_u32 v9, v9, v11
    v_subrev_u32 v11, 2, v9
    v_max_u32 v11, 16, v11
    v_min_u32 v9, v9, v11
    v_mul_u32_u24 v10, 3456, v10
    v_lshl_add_u32 v6, v9, 4, v10
    s_add_u32 m0, s68, 2048
    s_add_u32 s71, s65, 0
    buffer_load_dwordx4 v6, s[12:15], s71 offen lds
    s_add_u32 m0, s68, 7168
    s_add_u32 s71, s65, 55296
    buffer_load_dwordx4 v6, s[12:15], s71 offen lds
    v_add_u32 v9, 192, v1
    v_mul_u32_u24 v10, 205, v9
    v_lshrrev_b32 v10, 12, v10
    v_mul_u32_u24 v11, 20, v10
    v_sub_u32 v9, v9, v11
    v_subrev_u32 v11, 2, v9
    v_max_u32 v11, 16, v11
    v_min_u32 v9, v9, v11
    v_mul_u32_u24 v10, 3456, v10
    v_lshl_add_u32 v7, v9, 4, v10
    s_add_u32 m0, s68, 3072
    s_add_u32 s71, s65, 0
    buffer_load_dwordx4 v7, s[12:15], s71 offen lds
    s_add_u32 m0, s68, 8192
    s_add_u32 s71, s65, 55296
    buffer_load_dwordx4 v7, s[12:15], s71 offen lds
    v_add_u32 v9, 256, v1
    v_mul_u32_u24 v10, 205, v9
    v_lshrrev_b32 v10, 12, v10
    v_mul_u32_u24 v11, 20, v10
    v_sub_u32 v9, v9, v11
    v_subrev_u32 v11, 2, v9
    v_max_u32 v11, 16, v11
    v_min_u32 v9, v9, v11
    v_mul_u32_u24 v10, 3456, v10
    v_lshl_add_u32 v8, v9, 4, v10
    s_add_u32 m0, s68, 4096
    s_add_u32 s71, s65, 0
    buffer_load_dwordx4 v8, s[12:15], s71 offen lds
    s_add_u32 m0, s68, 9216
    s_add_u32 s71, s65, 55296
    buffer_load_dwordx4 v8, s[12:15], s71 offen lds
    s_add_u32 s64, s64, 128
    s_add_u32 s65, s65, 221184
    s_add_u32 m0, s67, 16384
    s_add_u32 s71, s64, 0
    buffer_load_dwordx4 v2, s[8:11], s71 offen lds
    s_add_u32 m0, s68, 20480
    s_add_u32 s71, s65, 0
    buffer_load_dwordx4 v4, s[12:15], s71 offen lds
    s_add_u32 m0, s67, 17408
    s_add_u32 s71, s64, 0
    buffer_load_dwordx4 v3, s[8:11], s71 offen lds
    s_add_u32 m0, s68, 21504
    s_add_u32 s71, s65, 0
    buffer_load_dwordx4 v5, s[12:15], s71 offen lds
    s_add_u32 m0, s67, 18432
    s_add_u32 s71, s64, 18432
    buffer_load_dwordx4 v2, s[8:11], s71 offen lds
    s_add_u32 m0, s68, 22528
    s_add_u32 s71, s65, 0
    buffer_load_dwordx4 v6, s[12:15], s71 offen lds
    s_add_u32 m0, s67, 19456
    s_add_u32 s71, s64, 18432
    buffer_load_dwordx4 v3, s[8:11], s71 offen lds
    s_add_u32 m0, s68, 23552
    s_add_u32 s71, s65, 0
    buffer_load_dwordx4 v7, s[12:15], s71 offen lds
    s_add_u32 m0, s67, 20480
    s_add_u32 s71, s64, 36864
    buffer_load_dwordx4 v2, s[8:11], s71 offen lds
    s_add_u32 m0, s68, 24576
    s_add_u32 s71, s65, 0
    buffer_load_dwordx4 v8, s[12:15], s71 offen lds
    s_add_u32 m0, s67, 21504
    s_add_u32 s71, s64, 36864
    buffer_load_dwordx4 v3, s[8:11], s71 offen lds
    s_add_u32 m0, s68, 25600
    s_add_u32 s71, s65, 55296
    buffer_load_dwordx4 v4, s[12:15], s71 offen lds
    s_add_u32 m0, s67, 22528
    s_add_u32 s71, s64, 55296
    buffer_load_dwordx4 v2, s[8:11], s71 offen lds
    s_add_u32 m0, s68, 26624
    s_add_u32 s71, s65, 55296
    buffer_load_dwordx4 v5, s[12:15], s71 offen lds
    s_add_u32 m0, s67, 23552
    s_add_u32 s71, s64, 55296
    buffer_load_dwordx4 v3, s[8:11], s71 offen lds
    s_add_u32 m0, s68, 27648
    s_add_u32 s71, s65, 55296
    buffer_load_dwordx4 v6, s[12:15], s71 offen lds
    s_add_u32 m0, s68, 28672
    s_add_u32 s71, s65, 55296
    buffer_load_dwordx4 v7, s[12:15], s71 offen lds
    s_add_u32 m0, s68, 29696
    s_add_u32 s71, s65, 55296
    buffer_load_dwordx4 v8, s[12:15], s71 offen lds
    s_waitcnt vmcnt(18)
    s_barrier
    s_add_u32 s64, s64, 128
    s_add_u32 s65, s65, 221184
    s_add_u32 m0, s67, 32768
    s_add_u32 s71, s64, 0
    buffer_load_dwordx4 v2, s[8:11], s71 offen lds
    s_add_u32 m0, s68, 40960
    s_add_u32 s71, s65, 0
    buffer_load_dwordx4 v4, s[12:15], s71 offen lds
    s_add_u32 m0, s67, 33792
    s_add_u32 s71, s64, 0
    buffer_load_dwordx4 v3, s[8:11], s71 offen lds
    s_add_u32 m0, s68, 41984
    s_add_u32 s71, s65, 0
    buffer_load_dwordx4 v5, s[12:15], s71 offen lds
    s_add_u32 m0, s67, 34816
    s_add_u32 s71, s64, 18432
    buffer_load_dwordx4 v2, s[8:11], s71 offen lds
    s_add_u32 m0, s68, 43008
    s_add_u32 s71, s65, 0
    buffer_load_dwordx4 v6, s[12:15], s71 offen lds
    s_add_u32 m0, s67, 35840
    s_add_u32 s71, s64, 18432
    buffer_load_dwordx4 v3, s[8:11], s71 offen lds
    s_add_u32 m0, s68, 44032
    s_add_u32 s71, s65, 0
    buffer_load_dwordx4 v7, s[12:15], s71 offen lds
    s_add_u32 m0, s67, 36864
    s_add_u32 s71, s64, 36864
    buffer_load_dwordx4 v2, s[8:11], s71 offen lds
    s_add_u32 m0, s68, 45056
    s_add_u32 s71, s65, 0
    buffer_load_dwordx4 v8, s[12:15], s71 offen lds
    s_add_u32 m0, s67, 37888
    s_add_u32 s71, s64, 36864
    buffer_load_dwordx4 v3, s[8:11], s71 offen lds
    s_add_u32 m0, s68, 46080
    s_add_u32 s71, s65, 55296
    buffer_load_dwordx4 v4, s[12:15], s71 offen lds
    s_add_u32 m0, s67, 38912
    s_add_u32 s71, s64, 55296
    buffer_load_dwordx4 v2, s[8:11], s71 offen lds
    s_add_u32 m0, s68, 47104
    s_add_u32 s71, s65, 55296
    buffer_load_dwordx4 v5, s[12:15], s71 offen lds
    s_add_u32 m0, s67, 39936
    s_add_u32 s71, s64, 55296
    buffer_load_dwordx4 v3, s[8:11], s71 offen lds
    s_add_u32 m0, s68, 48128
    s_add_u32 s71, s65, 55296
    buffer_load_dwordx4 v6, s[12:15], s71 offen lds
    s_add_u32 m0, s68, 49152
    s_add_u32 s71, s65, 55296
    buffer_load_dwordx4 v7, s[12:15], s71 offen lds
    s_add_u32 m0, s68, 50176
    s_add_u32 s71, s65, 55296
    buffer_load_dwordx4 v8, s[12:15], s71 offen lds
    s_waitcnt vmcnt(18)
    s_barrier
    s_add_u32 s64, s64, 128
    s_add_u32 s65, s65, 221184
    s_cmp_eq_u32 s66, 6
    s_cselect_b32 s69, 1152, 0
    s_cselect_b32 s70, 1990656, 0
    s_sub_u32 s64, s64, s69
    s_sub_u32 s65, s65, s70
    s_add_u32 m0, s67, 0
    s_add_u32 s71, s64, 0
    buffer_load_dwordx4 v2, s[8:11], s71 offen lds
    s_add_u32 m0, s68, 0
    s_add_u32 s71, s65, 0
    buffer_load_dwordx4 v4, s[12:15], s71 offen lds
    s_add_u32 m0, s67, 1024
    s_add_u32 s71, s64, 0
    buffer_load_dwordx4 v3, s[8:11], s71 offen lds
    s_add_u32 m0, s68, 1024
    s_add_u32 s71, s65, 0
    buffer_load_dwordx4 v5, s[12:15], s71 offen lds
    s_add_u32 m0, s67, 2048
    s_add_u32 s71, s64, 18432
    buffer_load_dwordx4 v2, s[8:11], s71 offen lds
    s_add_u32 m0, s68, 2048
    s_add_u32 s71, s65, 0
    buffer_load_dwordx4 v6, s[12:15], s71 offen lds
    s_add_u32 m0, s67, 3072
    s_add_u32 s71, s64, 18432
    buffer_load_dwordx4 v3, s[8:11], s71 offen lds
    s_add_u32 m0, s68, 3072
    s_add_u32 s71, s65, 0
    buffer_load_dwordx4 v7, s[12:15], s71 offen lds
    s_add_u32 m0, s67, 4096
    s_add_u32 s71, s64, 36864
    buffer_load_dwordx4 v2, s[8:11], s71 offen lds
    s_add_u32 m0, s68, 4096
    s_add_u32 s71, s65, 0
    buffer_load_dwordx4 v8, s[12:15], s71 offen lds
    s_add_u32 m0, s67, 5120
    s_add_u32 s71, s64, 36864
    buffer_load_dwordx4 v3, s[8:11], s71 offen lds
    s_add_u32 m0, s68, 5120
    s_add_u32 s71, s65, 55296
    buffer_load_dwordx4 v4, s[12:15], s71 offen lds
    s_add_u32 m0, s67, 6144
    s_add_u32 s71, s64, 55296
    buffer_load_dwordx4 v2, s[8:11], s71 offen lds
    s_add_u32 m0, s68, 6144
    s_add_u32 s71, s65, 55296
    buffer_load_dwordx4 v5, s[12:15], s71 offen lds
    s_add_u32 m0, s67, 7168
    s_add_u32 s71, s64, 55296
    buffer_load_dwordx4 v3, s[8:11], s71 offen lds
    s_add_u32 m0, s68, 7168
    s_add_u32 s71, s65, 55296
    buffer_load_dwordx4 v6, s[12:15], s71 offen lds
    s_add_u32 m0, s68, 8192
    s_add_u32 s71, s65, 55296
    buffer_load_dwordx4 v7, s[12:15], s71 offen lds
    s_add_u32 m0, s68, 9216
    s_add_u32 s71, s65, 55296
    buffer_load_dwordx4 v8, s[12:15], s71 offen lds
    s_waitcnt vmcnt(18)
    s_barrier
    s_add_u32 s64, s64, 128
    s_add_u32 s65, s65, 221184
    s_add_u32 m0, s67, 16384
    s_add_u32 s71, s64, 0
    buffer_load_dwordx4 v2, s[8:11], s71 offen lds
    s_add_u32 m0, s68, 20480
    s_add_u32 s71, s65, 0
    buffer_load_dwordx4 v4, s[12:15], s71 offen lds
    s_add_u32 m0, s67, 17408
    s_add_u32 s71, s64, 0
    buffer_load_dwordx4 v3, s[8:11], s71 offen lds
    s_add_u32 m0, s68, 21504
    s_add_u32 s71, s65, 0
    buffer_load_dwordx4 v5, s[12:15], s71 offen lds
    s_add_u32 m0, s67, 18432
    s_add_u32 s71, s64, 18432
    buffer_load_dwordx4 v2, s[8:11], s71 offen lds
    s_add_u32 m0, s68, 22528
    s_add_u32 s71, s65, 0
    buffer_load_dwordx4 v6, s[12:15], s71 offen lds
    s_add_u32 m0, s67, 19456
    s_add_u32 s71, s64, 18432
    buffer_load_dwordx4 v3, s[8:11], s71 offen lds
    s_add_u32 m0, s68, 23552
    s_add_u32 s71, s65, 0
    buffer_load_dwordx4 v7, s[12:15], s71 offen lds
    s_add_u32 m0, s67, 20480
    s_add_u32 s71, s64, 36864
    buffer_load_dwordx4 v2, s[8:11], s71 offen lds
    s_add_u32 m0, s68, 24576
    s_add_u32 s71, s65, 0
    buffer_load_dwordx4 v8, s[12:15], s71 offen lds
    s_add_u32 m0, s67, 21504
    s_add_u32 s71, s64, 36864
    buffer_load_dwordx4 v3, s[8:11], s71 offen lds
    s_add_u32 m0, s68, 25600
    s_add_u32 s71, s65, 55296
    buffer_load_dwordx4 v4, s[12:15], s71 offen lds
    s_add_u32 m0, s67, 22528
    s_add_u32 s71, s64, 55296
    buffer_load_dwordx4 v2, s[8:11], s71 offen lds
    s_add_u32 m0, s68, 26624
    s_add_u32 s71, s65, 55296
    buffer_load_dwordx4 v5, s[12:15], s71 offen lds
    s_add_u32 m0, s67, 23552
    s_add_u32 s71, s64, 55296
    buffer_load_dwordx4 v3, s[8:11], s71 offen lds
    s_add_u32 m0, s68, 27648
    s_add_u32 s71, s65, 55296
    buffer_load_dwordx4 v6, s[12:15], s71 offen lds
    s_add_u32 m0, s68, 28672
    s_add_u32 s71, s65, 55296
    buffer_load_dwordx4 v7, s[12:15], s71 offen lds
    s_add_u32 m0, s68, 29696
    s_add_u32 s71, s65, 55296
    buffer_load_dwordx4 v8, s[12:15], s71 offen lds
    s_waitcnt vmcnt(18)
    s_barrier
    s_add_u32 s64, s64, 128
    s_add_u32 s65, s65, 221184
    s_add_u32 m0, s67, 32768
    s_add_u32 s71, s64, 0
    buffer_load_dwordx4 v2, s[8:11], s71 offen lds
    s_add_u32 m0, s68, 40960
    s_add_u32 s71, s65, 0
    buffer_load_dwordx4 v4, s[12:15], s71 offen lds
    s_add_u32 m0, s67, 33792
    s_add_u32 s71, s64, 0
    buffer_load_dwordx4 v3, s[8:11], s71 offen lds
    s_add_u32 m0, s68, 41984
    s_add_u32 s71, s65, 0
    buffer_load_dwordx4 v5, s[12:15], s71 offen lds
    s_add_u32 m0, s67, 34816
    s_add_u32 s71, s64, 18432
    buffer_load_dwordx4 v2, s[8:11], s71 offen lds
    s_add_u32 m0, s68, 43008
    s_add_u32 s71, s65, 0
    buffer_load_dwordx4 v6, s[12:15], s71 offen lds
    s_add_u32 m0, s67, 35840
    s_add_u32 s71, s64, 18432
    buffer_load_dwordx4 v3, s[8:11], s71 offen lds
    s_add_u32 m0, s68, 44032
    s_add_u32 s71, s65, 0
    buffer_load_dwordx4 v7, s[12:15], s71 offen lds
    s_add_u32 m0, s67, 36864
    s_add_u32 s71, s64, 36864
    buffer_load_dwordx4 v2, s[8:11], s71 offen lds
    s_add_u32 m0, s68, 45056
    s_add_u32 s71, s65, 0
    buffer_load_dwordx4 v8, s[12:15], s71 offen lds
    s_add_u32 m0, s67, 37888
    s_add_u32 s71, s64, 36864
    buffer_load_dwordx4 v3, s[8:11], s71 offen lds
    s_add_u32 m0, s68, 46080
    s_add_u32 s71, s65, 55296
    buffer_load_dwordx4 v4, s[12:15], s71 offen lds
    s_add_u32 m0, s67, 38912
    s_add_u32 s71, s64, 55296
    buffer_load_dwordx4 v2, s[8:11], s71 offen lds
    s_add_u32 m0, s68, 47104
    s_add_u32 s71, s65, 55296
    buffer_load_dwordx4 v5, s[12:15], s71 offen lds
    s_add_u32 m0, s67, 39936
    s_add_u32 s71, s64, 55296
    buffer_load_dwordx4 v3, s[8:11], s71 offen lds
    s_add_u32 m0, s68, 48128
    s_add_u32 s71, s65, 55296
    buffer_load_dwordx4 v6, s[12:15], s71 offen lds
    s_add_u32 m0, s68, 49152
    s_add_u32 s71, s65, 55296
    buffer_load_dwordx4 v7, s[12:15], s71 offen lds
    s_add_u32 m0, s68, 50176
    s_add_u32 s71, s65, 55296
    buffer_load_dwordx4 v8, s[12:15], s71 offen lds
    s_waitcnt vmcnt(18)
    s_barrier
    s_add_u32 s64, s64, 128
    s_add_u32 s65, s65, 221184
    s_cmp_eq_u32 s66, 3
    s_cselect_b32 s69, 1152, 0
    s_cselect_b32 s70, 1990656, 0
    s_sub_u32 s64, s64, s69
    s_sub_u32 s65, s65, s70
    s_add_u32 m0, s67, 0
    s_add_u32 s71, s64, 0
    buffer_load_dwordx4 v2, s[8:11], s71 offen lds
    s_add_u32 m0, s68, 0
    s_add_u32 s71, s65, 0
    buffer_load_dwordx4 v4, s[12:15], s71 offen lds
    s_add_u32 m0, s67, 1024
    s_add_u32 s71, s64, 0
    buffer_load_dwordx4 v3, s[8:11], s71 offen lds
    s_add_u32 m0, s68, 1024
    s_add_u32 s71, s65, 0
    buffer_load_dwordx4 v5, s[12:15], s71 offen lds
    s_add_u32 m0, s67, 2048
    s_add_u32 s71, s64, 18432
    buffer_load_dwordx4 v2, s[8:11], s71 offen lds
    s_add_u32 m0, s68, 2048
    s_add_u32 s71, s65, 0
    buffer_load_dwordx4 v6, s[12:15], s71 offen lds
    s_add_u32 m0, s67, 3072
    s_add_u32 s71, s64, 18432
    buffer_load_dwordx4 v3, s[8:11], s71 offen lds
    s_add_u32 m0, s68, 3072
    s_add_u32 s71, s65, 0
    buffer_load_dwordx4 v7, s[12:15], s71 offen lds
    s_add_u32 m0, s67, 4096
    s_add_u32 s71, s64, 36864
    buffer_load_dwordx4 v2, s[8:11], s71 offen lds
    s_add_u32 m0, s68, 4096
    s_add_u32 s71, s65, 0
    buffer_load_dwordx4 v8, s[12:15], s71 offen lds
    s_add_u32 m0, s67, 5120
    s_add_u32 s71, s64, 36864
    buffer_load_dwordx4 v3, s[8:11], s71 offen lds
    s_add_u32 m0, s68, 5120
    s_add_u32 s71, s65, 55296
    buffer_load_dwordx4 v4, s[12:15], s71 offen lds
    s_add_u32 m0, s67, 6144
    s_add_u32 s71, s64, 55296
    buffer_load_dwordx4 v2, s[8:11], s71 offen lds
    s_add_u32 m0, s68, 6144
    s_add_u32 s71, s65, 55296
    buffer_load_dwordx4 v5, s[12:15], s71 offen lds
    s_add_u32 m0, s67, 7168
    s_add_u32 s71, s64, 55296
    buffer_load_dwordx4 v3, s[8:11], s71 offen lds
    s_add_u32 m0, s68, 7168
    s_add_u32 s71, s65, 55296
    buffer_load_dwordx4 v6, s[12:15], s71 offen lds
    s_add_u32 m0, s68, 8192
    s_add_u32 s71, s65, 55296
    buffer_load_dwordx4 v7, s[12:15], s71 offen lds
    s_add_u32 m0, s68, 9216
    s_add_u32 s71, s65, 55296
    buffer_load_dwordx4 v8, s[12:15], s71 offen lds
    s_waitcnt vmcnt(18)
    s_barrier
    s_add_u32 s64, s64, 128
    s_add_u32 s65, s65, 221184
    s_add_u32 m0, s67, 16384
    s_add_u32 s71, s64, 0
    buffer_load_dwordx4 v2, s[8:11], s71 offen lds
    s_add_u32 m0, s68, 20480
    s_add_u32 s71, s65, 0
    buffer_load_dwordx4 v4, s[12:15], s71 offen lds
    s_add_u32 m0, s67, 17408
    s_add_u32 s71, s64, 0
    buffer_load_dwordx4 v3, s[8:11], s71 offen lds
    s_add_u32 m0, s68, 21504
    s_add_u32 s71, s65, 0
    buffer_load_dwordx4 v5, s[12:15], s71 offen lds
    s_add_u32 m0, s67, 18432
    s_add_u32 s71, s64, 18432
    buffer_load_dwordx4 v2, s[8:11], s71 offen lds
    s_add_u32 m0, s68, 22528
    s_add_u32 s71, s65, 0
    buffer_load_dwordx4 v6, s[12:15], s71 offen lds
    s_add_u32 m0, s67, 19456
    s_add_u32 s71, s64, 18432
    buffer_load_dwordx4 v3, s[8:11], s71 offen lds
    s_add_u32 m0, s68, 23552
    s_add_u32 s71, s65, 0
    buffer_load_dwordx4 v7, s[12:15], s71 offen lds
    s_add_u32 m0, s67, 20480
    s_add_u32 s71, s64, 36864
    buffer_load_dwordx4 v2, s[8:11], s71 offen lds
    s_add_u32 m0, s68, 24576
    s_add_u32 s71, s65, 0
    buffer_load_dwordx4 v8, s[12:15], s71 offen lds
    s_add_u32 m0, s67, 21504
    s_add_u32 s71, s64, 36864
    buffer_load_dwordx4 v3, s[8:11], s71 offen lds
    s_add_u32 m0, s68, 25600
    s_add_u32 s71, s65, 55296
    buffer_load_dwordx4 v4, s[12:15], s71 offen lds
    s_add_u32 m0, s67, 22528
    s_add_u32 s71, s64, 55296
    buffer_load_dwordx4 v2, s[8:11], s71 offen lds
    s_add_u32 m0, s68, 26624
    s_add_u32 s71, s65, 55296
    buffer_load_dwordx4 v5, s[12:15], s71 offen lds
    s_add_u32 m0, s67, 23552
    s_add_u32 s71, s64, 55296
    buffer_load_dwordx4 v3, s[8:11], s71 offen lds
    s_add_u32 m0, s68, 27648
    s_add_u32 s71, s65, 55296
    buffer_load_dwordx4 v6, s[12:15], s71 offen lds
    s_add_u32 m0, s68, 28672
    s_add_u32 s71, s65, 55296
    buffer_load_dwordx4 v7, s[12:15], s71 offen lds
    s_add_u32 m0, s68, 29696
    s_add_u32 s71, s65, 55296
    buffer_load_dwordx4 v8, s[12:15], s71 offen lds
    s_waitcnt vmcnt(18)
    s_barrier
    s_add_u32 s64, s64, 128
    s_add_u32 s65, s65, 221184
    s_add_u32 m0, s67, 32768
    s_add_u32 s71, s64, 0
    buffer_load_dwordx4 v2, s[8:11], s71 offen lds
    s_add_u32 m0, s68, 40960
    s_add_u32 s71, s65, 0
    buffer_load_dwordx4 v4, s[12:15], s71 offen lds
    s_add_u32 m0, s67, 33792
    s_add_u32 s71, s64, 0
    buffer_load_dwordx4 v3, s[8:11], s71 offen lds
    s_add_u32 m0, s68, 41984
    s_add_u32 s71, s65, 0
    buffer_load_dwordx4 v5, s[12:15], s71 offen lds
    s_add_u32 m0, s67, 34816
    s_add_u32 s71, s64, 18432
    buffer_load_dwordx4 v2, s[8:11], s71 offen lds
    s_add_u32 m0, s68, 43008
    s_add_u32 s71, s65, 0
    buffer_load_dwordx4 v6, s[12:15], s71 offen lds
    s_add_u32 m0, s67, 35840
    s_add_u32 s71, s64, 18432
    buffer_load_dwordx4 v3, s[8:11], s71 offen lds
    s_add_u32 m0, s68, 44032
    s_add_u32 s71, s65, 0
    buffer_load_dwordx4 v7, s[12:15], s71 offen lds
    s_add_u32 m0, s67, 36864
    s_add_u32 s71, s64, 36864
    buffer_load_dwordx4 v2, s[8:11], s71 offen lds
    s_add_u32 m0, s68, 45056
    s_add_u32 s71, s65, 0
    buffer_load_dwordx4 v8, s[12:15], s71 offen lds
    s_add_u32 m0, s67, 37888
    s_add_u32 s71, s64, 36864
    buffer_load_dwordx4 v3, s[8:11], s71 offen lds
    s_add_u32 m0, s68, 46080
    s_add_u32 s71, s65, 55296
    buffer_load_dwordx4 v4, s[12:15], s71 offen lds
    s_add_u32 m0, s67, 38912
    s_add_u32 s71, s64, 55296
    buffer_load_dwordx4 v2, s[8:11], s71 offen lds
    s_add_u32 m0, s68, 47104
    s_add_u32 s71, s65, 55296
    buffer_load_dwordx4 v5, s[12:15], s71 offen lds
    s_add_u32 m0, s67, 39936
    s_add_u32 s71, s64, 55296
    buffer_load_dwordx4 v3, s[8:11], s71 offen lds
    s_add_u32 m0, s68, 48128
    s_add_u32 s71, s65, 55296
    buffer_load_dwordx4 v6, s[12:15], s71 offen lds
    s_add_u32 m0, s68, 49152
    s_add_u32 s71, s65, 55296
    buffer_load_dwordx4 v7, s[12:15], s71 offen lds
    s_add_u32 m0, s68, 50176
    s_add_u32 s71, s65, 55296
    buffer_load_dwordx4 v8, s[12:15], s71 offen lds
    s_waitcnt vmcnt(18)
    s_barrier
    s_waitcnt vmcnt(0)
    s_barrier
    s_lshl_b32 s84, s63, 4
    s_add_u32 s84, s84, s62
    s_lshl_b32 s84, s84, 7
    s_add_u32 s84, s84, 14548992
    s_mov_b32 s92, 110592
    s_mul_i32 s93, s60, 24
    s_add_u32 s93, s93, s61
    s_lshl_b32 s93, s93, 1
    s_mov_b32 s94, 4
    s_sub_u32 s91, s3, 6
    s_mul_i32 s85, s60, 24
    s_add_u32 s85, s85, s61
    s_lshl_b32 s87, s60, 3
    s_add_u32 s87, s87, s61
    s_add_u32 s87, s87, 168
    s_cmp_lt_u32 s61, 24
    s_cselect_b32 s85, s85, s87
    s_lshl_b32 s85, s85, 7
    s_add_u32 s85, s85, 14581760
    s_and_b32 s86, s61, 7
    s_lshl_b32 s86, s86, 5
    s_lshl_b32 s87, s60, 2
    s_add_u32 s86, s86, s87
    s_lshr_b32 s87, s61, 3
    s_add_u32 s86, s86, s87
    s_lshl_b32 s86, s86, 7
    s_add_u32 s86, s86, 14614528
    s_and_b32 s70, s63, 3
    s_lshl_b32 s70, s70, 3
    s_lshr_b32 s71, s62, 1
    s_mul_i32 s71, s71, 18944
    s_add_u32 s71, s71, 0
    s_and_b32 s72, s62, 1
    s_lshl_b32 s73, s72, 12
    s_add_u32 s73, s73, s71
    s_mul_i32 s79, s72, 4864
    s_add_u32 s79, s79, s71
    s_add_u32 s79, s79, 9216
    s_lshl_b32 s75, s72, 9
    s_add_u32 s75, s75, s71
    s_add_u32 s75, s75, 8192
    s_cmp_ge_u32 s63, 8
    s_cselect_b32 s73, s79, s73
    s_lshl_b32 s74, s62, 12
    s_add_u32 s74, s74, 4849664
    s_lshl_b32 s76, s62, 9
    s_add_u32 s76, s76, 6946816
    s_mov_b32 s78, 151552
    s_cmp_lt_u32 s63, 4
    s_cselect_b32 s73, s74, s73
    s_cselect_b32 s75, s76, s75
    s_cselect_b32 s74, 65536, s78
    s_cselect_b32 s72, 8192, s78
    s_cselect_b32 s76, 0x3eae1a93, 1.0
    s_mov_b32 s77, s76
    s_mul_i32 s78, s70, s74
    s_add_u32 s73, s73, s78
    s_mul_i32 s78, s70, s72
    s_add_u32 s75, s75, s78
    s_mov_b32 s82, s73
    s_mov_b32 s83, s75
    s_mov_b32 s90, s72
    v_mov_b32 v246, 0
    s_mov_b32 s87, 0
L_spin_14:
    global_load_dwordx2 v[250:251], v246, s[48:49] sc1
    s_waitcnt vmcnt(0)
    v_cmp_eq_u32 vcc, 0, v250
    s_add_u32 s87, s87, 1
    s_cbranch_vccz L_spun_15
    s_sleep 2
    s_cmp_lt_u32 s87, 65536
    s_cbranch_scc1 L_spin_14
L_spun_15:
    s_barrier
    s_cmp_ge_u32 s63, 8
    s_cbranch_scc1 L_flv_16
    s_and_b32 s69, s3, 1
    s_lshl_b32 s70, s69, 11
    s_add_u32 s70, s70, 49152
    v_lshl_add_u32 v200, v1, 4, s70
    ds_read_b128 v[204:207], v200
    ds_read_b128 v[208:211], v200 offset:1024
    v_lshrrev_b32 v201, 5, v1
    v_and_b32 v202, 31, v1
    v_mul_lo_u32 v201, v201, s90
    v_lshl_add_u32 v201, v202, 4, v201
    s_lshl_b32 s69, s69, 2
    s_mul_i32 s69, s69, s90
    s_add_u32 s69, s69, s83
    s_lshl_b32 s70, s90, 1
    s_add_u32 s70, s70, s69
    s_waitcnt lgkmcnt(1)
    buffer_store_dwordx4 v[204:207], v201, s[16:19], s69 offen sc1
    s_waitcnt lgkmcnt(0)
    buffer_store_dwordx4 v[208:211], v201, s[16:19], s70 offen sc1
    s_branch L_fle_17
L_flv_16:
    v_subrev_u32 v202, 256, v0
    v_lshlrev_b32 v200, 4, v202
    v_add_u32 v201, 49152, v200
    s_mov_b32 s69, 146688
    ds_read_b128 v[204:207], v201 offset:0
    ds_read_b128 v[208:211], v201 offset:2048
    ds_read_b128 v[212:215], v201 offset:4096
    v_add_u32 v200, 0, v202
    v_mul_u32_u24 v201, 171, v200
    v_lshlrev_b32 v200, 4, v200
    v_lshrrev_b32 v201, 11, v201
    v_lshl_add_u32 v200, v201, 10, v200
    v_lshrrev_b32 v201, 2, v201
    v_mul_lo_u32 v201, v201, s69
    v_add_u32 v200, v200, v201
    s_waitcnt lgkmcnt(2)
    buffer_store_dwordx4 v[204:207], v200, s[16:19], s82 offen offset:1024 sc1
    v_add_u32 v200, 128, v202
    v_mul_u32_u24 v201, 171, v200
    v_lshlrev_b32 v200, 4, v200
    v_lshrrev_b32 v201, 11, v201
    v_lshl_add_u32 v200, v201, 10, v200
    v_lshrrev_b32 v201, 2, v201
    v_mul_lo_u32 v201, v201, s69
    v_add_u32 v200, v200, v201
    s_waitcnt lgkmcnt(1)
    buffer_store_dwordx4 v[208:211], v200, s[16:19], s82 offen offset:1024 sc1
    v_add_u32 v200, 256, v202
    v_mul_u32_u24 v201, 171, v200
    v_lshlrev_b32 v200, 4, v200
    v_lshrrev_b32 v201, 11, v201
    v_lshl_add_u32 v200, v201, 10, v200
    v_lshrrev_b32 v201, 2, v201
    v_mul_lo_u32 v201, v201, s69
    v_add_u32 v200, v200, v201
    s_waitcnt lgkmcnt(0)
    buffer_store_dwordx4 v[212:215], v200, s[16:19], s82 offen offset:1024 sc1
L_fle_17:
    s_branch L_join
L_nold_13:
    s_lshl_b32 s84, s63, 4
    s_add_u32 s84, s84, s62
    s_lshl_b32 s84, s84, 7
    s_add_u32 s84, s84, 14548992
    s_mov_b32 s92, 110592
    s_mul_i32 s93, s60, 24
    s_add_u32 s93, s93, s61
    s_lshl_b32 s93, s93, 1
    s_mov_b32 s94, 4
    s_sub_u32 s91, s3, 6
    s_cmp_ge_u32 s3, 6
    s_cbranch_scc1 L_kg_6
    s_lshr_b32 s96, s3, 1
    s_and_b32 s97, s3, 1
    s_add_u32 s98, s96, s93
    s_lshl_b32 s99, s98, 7
    s_add_u32 s99, s99, s97
    s_lshl_b32 s99, s99, 1
    v_lshl_add_u32 v226, v1, 2, s99
    s_lshl_b32 s98, s98, 1
    v_mov_b32 v227, s98
    global_load_ushort v228, v226, s[32:33]
    global_load_ushort v229, v226, s[34:35]
    global_load_ushort v230, v227, s[44:45]
    s_mul_i32 s96, s96, 25328
    s_add_u32 s96, s96, s92
    s_cmp_eq_u32 s97, 0
    s_cselect_b32 s97, 16624, 0
    s_add_u32 s89, s96, s97
    s_and_b32 s70, s63, 3
    s_lshl_b32 s70, s70, 3
    s_lshr_b32 s71, s62, 1
    s_mul_i32 s71, s71, 18944
    s_add_u32 s71, s71, 0
    s_and_b32 s72, s62, 1
    s_lshl_b32 s73, s72, 12
    s_add_u32 s73, s73, s71
    s_mul_i32 s79, s72, 4864
    s_add_u32 s79, s79, s71
    s_add_u32 s79, s79, 9216
    s_lshl_b32 s75, s72, 9
    s_add_u32 s75, s75, s71
    s_add_u32 s75, s75, 8192
    s_cmp_ge_u32 s63, 8
    s_cselect_b32 s73, s79, s73
    s_lshl_b32 s74, s62, 12
    s_add_u32 s74, s74, 4849664
    s_lshl_b32 s76, s62, 9
    s_add_u32 s76, s76, 6946816
    s_mov_b32 s78, 151552
    s_cmp_lt_u32 s63, 4
    s_cselect_b32 s73, s74, s73
    s_cselect_b32 s75, s76, s75
    s_cselect_b32 s74, 65536, s78
    s_cselect_b32 s72, 8192, s78
    s_cselect_b32 s76, 0x3eae1a93, 1.0
    s_mov_b32 s77, s76
    s_mul_i32 s78, s70, s74
    s_add_u32 s73, s73, s78
    s_mul_i32 s78, s70, s72
    s_add_u32 s75, s75, s78
    s_mov_b32 s82, s73
    s_mov_b32 s83, s75
    s_mov_b32 s90, s72
    s_cmp_ge_u32 s63, 8
    s_cbranch_scc1 L_v_4
    s_lshr_b32 s69, s3, 1
    s_and_b32 s70, s3, 1
    v_and_b32 v13, 31, v1
    v_lshrrev_b32 v14, 5, v1
    v_bfe_u32 v15, v1, 1, 3
    v_xor_b32 v15, v15, v14
    s_lshl_b32 s71, s3, 12
    v_lshlrev_b32 v13, 7, v13
    v_lshl_add_u32 v13, v15, 4, v13
    v_add_u32 v2, s71, v13
    v_xor_b32 v3, 32, v2
    v_xor_b32 v4, 64, v2
    v_xor_b32 v5, 0x60, v2
    v_xor_b32 v6, 0x1000, v2
    v_xor_b32 v7, 0x1000, v3
    v_xor_b32 v8, 0x1000, v4
    v_xor_b32 v9, 0x1000, v5
    v_bfe_u32 v13, v1, 2, 2
    v_lshl_add_u32 v13, v14, 3, v13
    v_mul_u32_u24 v13, 320, v13
    v_add_u32 v13, 49152, v13
    v_and_b32 v15, 3, v1
    v_bfe_u32 v16, v1, 4, 1
    v_lshl_add_u32 v14, v15, 3, v13
    v_lshl_add_u32 v13, v16, 5, v14
    s_cmp_eq_u32 s70, 0
    s_cselect_b32 s71, 256, 0
    s_cselect_b32 s78, 0, 112
    s_cselect_b32 s79, 40, 184
    v_mul_u32_u24 v10, s71, v16
    v_add3_u32 v10, v10, v13, s78
    v_add_u32 v11, s79, v13
    v_lshl_add_u32 v15, v15, 6, 32
    v_xor_b32 v16, 1, v16
    v_mul_u32_u24 v15, v15, v16
    v_add_u32 v12, v15, v14
    v_lshlrev_b32 v180, 4, v1
    s_lshl_b32 s71, s3, 10
    v_add_u32 v180, s71, v180
    v_xor_b32 v182, 0x400, v180
    v_lshrrev_b32 v14, 5, v1
    v_and_b32 v15, 31, v1
    v_lshlrev_b32 v14, 10, v14
    v_lshl_add_u32 v14, v15, 3, v14
    s_lshl_b32 s71, s69, 8
    s_lshl_b32 s78, s70, 2
    s_add_u32 s71, s71, s78
    s_add_u32 s71, s71, 49152
    v_add_u32 v181, s71, v14
    s_cmp_eq_u32 s70, 0
    s_cselect_b32 s64, 0, 3
    s_cselect_b32 s65, 7, 4
    s_cselect_b32 s66, 1, 5
    s_cselect_b32 s67, 2, 6
    s_mul_i32 s64, s64, s74
    s_mul_i32 s65, s65, s74
    s_mul_i32 s66, s66, s74
    s_mul_i32 s67, s67, s74
    s_add_u32 s64, s64, s73
    s_add_u32 s65, s65, s73
    s_add_u32 s66, s66, s73
    s_add_u32 s67, s67, s73
    s_waitcnt vmcnt(0)
    s_mov_b32 s100, 0
    s_branch L_kb_8
L_kbr_9:
    s_barrier
    ds_read_b128 v[20:23], v2 offset:0
    ds_read_b64_tr_b16 v[52:53], v10 offset:0
    ds_read_b64_tr_b16 v[54:55], v10 offset:1280
    ds_read_b128 v[24:27], v6 offset:0
    ds_read_b64_tr_b16 v[56:57], v11 offset:0
    ds_read_b64_tr_b16 v[58:59], v11 offset:1280
    ds_read_b64_tr_b16 v[60:61], v12 offset:0
    ds_read_b64_tr_b16 v[62:63], v12 offset:1280
    s_waitcnt lgkmcnt(5)
    v_mfma_f32_32x32x16_bf16 v[100:115], v[52:55], v[20:23], 0
    ds_read_b128 v[28:31], v3 offset:0
    ds_read_b64_tr_b16 v[64:65], v10 offset:5120
    s_waitcnt lgkmcnt(6)
    v_mfma_f32_32x32x16_bf16 v[116:131], v[52:55], v[24:27], 0
    ds_read_b64_tr_b16 v[66:67], v10 offset:6400
    ds_read_b128 v[32:35], v7 offset:0
    s_waitcnt lgkmcnt(6)
    v_mfma_f32_32x32x16_bf16 v[132:147], v[56:59], v[20:23], 0
    ds_read_b64_tr_b16 v[68:69], v11 offset:5120
    ds_read_b64_tr_b16 v[70:71], v11 offset:6400
    v_mfma_f32_32x32x16_bf16 v[148:163], v[56:59], v[24:27], 0
    ds_read_b64_tr_b16 v[72:73], v12 offset:5120
    ds_read_b64_tr_b16 v[74:75], v12 offset:6400
    s_waitcnt lgkmcnt(8)
    v_mfma_f32_32x32x16_bf16 v[164:179], v[60:63], v[20:23], 0
    s_waitcnt lgkmcnt(5)
    v_mfma_f32_32x32x16_bf16 v[100:115], v[64:67], v[28:31], v[100:115]
    ds_read_b128 v[20:23], v4 offset:0
    ds_read_b64_tr_b16 v[52:53], v10 offset:10240
    s_waitcnt lgkmcnt(6)
    v_mfma_f32_32x32x16_bf16 v[116:131], v[64:67], v[32:35], v[116:131]
    ds_read_b64_tr_b16 v[54:55], v10 offset:11520
    ds_read_b128 v[24:27], v8 offset:0
    s_waitcnt lgkmcnt(6)
    v_mfma_f32_32x32x16_bf16 v[132:147], v[68:71], v[28:31], v[132:147]
    ds_read_b64_tr_b16 v[56:57], v11 offset:10240
    ds_read_b64_tr_b16 v[58:59], v11 offset:11520
    v_mfma_f32_32x32x16_bf16 v[148:163], v[68:71], v[32:35], v[148:163]
    ds_read_b64_tr_b16 v[60:61], v12 offset:10240
    ds_read_b64_tr_b16 v[62:63], v12 offset:11520
    s_waitcnt lgkmcnt(8)
    v_mfma_f32_32x32x16_bf16 v[164:179], v[72:75], v[28:31], v[164:179]
    s_waitcnt lgkmcnt(5)
    v_mfma_f32_32x32x16_bf16 v[100:115], v[52:55], v[20:23], v[100:115]
    ds_read_b128 v[28:31], v5 offset:0
    ds_read_b64_tr_b16 v[64:65], v10 offset:15360
    s_waitcnt lgkmcnt(6)
    v_mfma_f32_32x32x16_bf16 v[116:131], v[52:55], v[24:27], v[116:131]
    ds_read_b64_tr_b16 v[66:67], v10 offset:16640
    ds_read_b128 v[32:35], v9 offset:0
    s_waitcnt lgkmcnt(6)
    v_mfma_f32_32x32x16_bf16 v[132:147], v[56:59], v[20:23], v[132:147]
    ds_read_b64_tr_b16 v[68:69], v11 offset:15360
    ds_read_b64_tr_b16 v[70:71], v11 offset:16640
    v_mfma_f32_32x32x16_bf16 v[148:163], v[56:59], v[24:27], v[148:163]
    ds_read_b64_tr_b16 v[72:73], v12 offset:15360
    ds_read_b64_tr_b16 v[74:75], v12 offset:16640
    s_waitcnt lgkmcnt(8)
    v_mfma_f32_32x32x16_bf16 v[164:179], v[60:63], v[20:23], v[164:179]
    s_waitcnt lgkmcnt(0)
    s_barrier
    v_mfma_f32_32x32x16_bf16 v[100:115], v[64:67], v[28:31], v[100:115]
    ds_read_b128 v[20:23], v2 offset:16384
    ds_read_b64_tr_b16 v[52:53], v10 offset:20480
    v_mfma_f32_32x32x16_bf16 v[116:131], v[64:67], v[32:35], v[116:131]
    ds_read_b64_tr_b16 v[54:55], v10 offset:21760
    ds_read_b128 v[24:27], v6 offset:16384
    v_mfma_f32_32x32x16_bf16 v[132:147], v[68:71], v[28:31], v[132:147]
    ds_read_b64_tr_b16 v[56:57], v11 offset:20480
    ds_read_b64_tr_b16 v[58:59], v11 offset:21760
    v_mfma_f32_32x32x16_bf16 v[148:163], v[68:71], v[32:35], v[148:163]
    ds_read_b64_tr_b16 v[60:61], v12 offset:20480
    ds_read_b64_tr_b16 v[62:63], v12 offset:21760
    v_mfma_f32_32x32x16_bf16 v[164:179], v[72:75], v[28:31], v[164:179]
    s_waitcnt lgkmcnt(5)
    v_mfma_f32_32x32x16_bf16 v[100:115], v[52:55], v[20:23], v[100:115]
    ds_read_b128 v[28:31], v3 offset:16384
    ds_read_b64_tr_b16 v[64:65], v10 offset:25600
    s_waitcnt lgkmcnt(6)
    v_mfma_f32_32x32x16_bf16 v[116:131], v[52:55], v[24:27], v[116:131]
    ds_read_b64_tr_b16 v[66:67], v10 offset:26880
    ds_read_b128 v[32:35], v7 offset:16384
    s_waitcnt lgkmcnt(6)
    v_mfma_f32_32x32x16_bf16 v[132:147], v[56:59], v[20:23], v[132:147]
    ds_read_b64_tr_b16 v[68:69], v11 offset:25600
    ds_read_b64_tr_b16 v[70:71], v11 offset:26880
    v_mfma_f32_32x32x16_bf16 v[148:163], v[56:59], v[24:27], v[148:163]
    ds_read_b64_tr_b16 v[72:73], v12 offset:25600
    ds_read_b64_tr_b16 v[74:75], v12 offset:26880
    s_waitcnt lgkmcnt(8)
    v_mfma_f32_32x32x16_bf16 v[164:179], v[60:63], v[20:23], v[164:179]
    s_waitcnt lgkmcnt(5)
    v_mfma_f32_32x32x16_bf16 v[100:115], v[64:67], v[28:31], v[100:115]
    ds_read_b128 v[20:23], v4 offset:16384
    ds_read_b64_tr_b16 v[52:53], v10 offset:30720
    s_waitcnt lgkmcnt(6)
    v_mfma_f32_32x32x16_bf16 v[116:131], v[64:67], v[32:35], v[116:131]
    ds_read_b64_tr_b16 v[54:55], v10 offset:32000
    ds_read_b128 v[24:27], v8 offset:16384
    s_waitcnt lgkmcnt(6)
    v_mfma_f32_32x32x16_bf16 v[132:147], v[68:71], v[28:31], v[132:147]
    ds_read_b64_tr_b16 v[56:57], v11 offset:30720
    ds_read_b64_tr_b16 v[58:59], v11 offset:32000
    v_mfma_f32_32x32x16_bf16 v[148:163], v[68:71], v[32:35], v[148:163]
    ds_read_b64_tr_b16 v[60:61], v12 offset:30720
    ds_read_b64_tr_b16 v[62:63], v12 offset:32000
    s_waitcnt lgkmcnt(8)
    v_mfma_f32_32x32x16_bf16 v[164:179], v[72:75], v[28:31], v[164:179]
    s_waitcnt lgkmcnt(5)
    v_mfma_f32_32x32x16_bf16 v[100:115], v[52:55], v[20:23], v[100:115]
    ds_read_b128 v[28:31], v5 offset:16384
    ds_read_b64_tr_b16 v[64:65], v10 offset:35840
    s_waitcnt lgkmcnt(6)
    v_mfma_f32_32x32x16_bf16 v[116:131], v[52:55], v[24:27], v[116:131]
    ds_read_b64_tr_b16 v[66:67], v10 offset:37120
    ds_read_b128 v[32:35], v9 offset:16384
    s_waitcnt lgkmcnt(6)
    v_mfma_f32_32x32x16_bf16 v[132:147], v[56:59], v[20:23], v[132:147]
    ds_read_b64_tr_b16 v[68:69], v11 offset:35840
    ds_read_b64_tr_b16 v[70:71], v11 offset:37120
    v_mfma_f32_32x32x16_bf16 v[148:163], v[56:59], v[24:27], v[148:163]
    ds_read_b64_tr_b16 v[72:73], v12 offset:35840
    ds_read_b64_tr_b16 v[74:75], v12 offset:37120
    s_waitcnt lgkmcnt(8)
    v_mfma_f32_32x32x16_bf16 v[164:179], v[60:63], v[20:23], v[164:179]
    s_waitcnt lgkmcnt(0)
    s_barrier
    v_mfma_f32_32x32x16_bf16 v[100:115], v[64:67], v[28:31], v[100:115]
    ds_read_b128 v[20:23], v2 offset:32768
    ds_read_b64_tr_b16 v[52:53], v10 offset:40960
    v_mfma_f32_32x32x16_bf16 v[116:131], v[64:67], v[32:35], v[116:131]
    ds_read_b64_tr_b16 v[54:55], v10 offset:42240
    ds_read_b128 v[24:27], v6 offset:32768
    v_mfma_f32_32x32x16_bf16 v[132:147], v[68:71], v[28:31], v[132:147]
    ds_read_b64_tr_b16 v[56:57], v11 offset:40960
    ds_read_b64_tr_b16 v[58:59], v11 offset:42240
    v_mfma_f32_32x32x16_bf16 v[148:163], v[68:71], v[32:35], v[148:163]
    ds_read_b64_tr_b16 v[60:61], v12 offset:40960
    ds_read_b64_tr_b16 v[62:63], v12 offset:42240
    v_mfma_f32_32x32x16_bf16 v[164:179], v[72:75], v[28:31], v[164:179]
    s_waitcnt lgkmcnt(5)
    v_mfma_f32_32x32x16_bf16 v[100:115], v[52:55], v[20:23], v[100:115]
    ds_read_b128 v[28:31], v3 offset:32768
    ds_read_b64_tr_b16 v[64:65], v10 offset:46080
    s_waitcnt lgkmcnt(6)
    v_mfma_f32_32x32x16_bf16 v[116:131], v[52:55], v[24:27], v[116:131]
    ds_read_b64_tr_b16 v[66:67], v10 offset:47360
    ds_read_b128 v[32:35], v7 offset:32768
    s_waitcnt lgkmcnt(6)
    v_mfma_f32_32x32x16_bf16 v[132:147], v[56:59], v[20:23], v[132:147]
    ds_read_b64_tr_b16 v[68:69], v11 offset:46080
    ds_read_b64_tr_b16 v[70:71], v11 offset:47360
    v_mfma_f32_32x32x16_bf16 v[148:163], v[56:59], v[24:27], v[148:163]
    ds_read_b64_tr_b16 v[72:73], v12 offset:46080
    ds_read_b64_tr_b16 v[74:75], v12 offset:47360
    s_waitcnt lgkmcnt(8)
    v_mfma_f32_32x32x16_bf16 v[164:179], v[60:63], v[20:23], v[164:179]
    s_waitcnt lgkmcnt(5)
    v_mfma_f32_32x32x16_bf16 v[100:115], v[64:67], v[28:31], v[100:115]
    ds_read_b128 v[20:23], v4 offset:32768
    ds_read_b64_tr_b16 v[52:53], v10 offset:51200
    s_waitcnt lgkmcnt(6)
    v_mfma_f32_32x32x16_bf16 v[116:131], v[64:67], v[32:35], v[116:131]
    ds_read_b64_tr_b16 v[54:55], v10 offset:52480
    ds_read_b128 v[24:27], v8 offset:32768
    s_waitcnt lgkmcnt(6)
    v_mfma_f32_32x32x16_bf16 v[132:147], v[68:71], v[28:31], v[132:147]
    ds_read_b64_tr_b16 v[56:57], v11 offset:51200
    ds_read_b64_tr_b16 v[58:59], v11 offset:52480
    v_mfma_f32_32x32x16_bf16 v[148:163], v[68:71], v[32:35], v[148:163]
    ds_read_b64_tr_b16 v[60:61], v12 offset:51200
    ds_read_b64_tr_b16 v[62:63], v12 offset:52480
    s_waitcnt lgkmcnt(8)
    v_mfma_f32_32x32x16_bf16 v[164:179], v[72:75], v[28:31], v[164:179]
    s_waitcnt lgkmcnt(5)
    v_mfma_f32_32x32x16_bf16 v[100:115], v[52:55], v[20:23], v[100:115]
    ds_read_b128 v[28:31], v5 offset:32768
    ds_read_b64_tr_b16 v[64:65], v10 offset:56320
    s_waitcnt lgkmcnt(6)
    v_mfma_f32_32x32x16_bf16 v[116:131], v[52:55], v[24:27], v[116:131]
    ds_read_b64_tr_b16 v[66:67], v10 offset:57600
    ds_read_b128 v[32:35], v9 offset:32768
    s_waitcnt lgkmcnt(6)
    v_mfma_f32_32x32x16_bf16 v[132:147], v[56:59], v[20:23], v[132:147]
    ds_read_b64_tr_b16 v[68:69], v11 offset:56320
    ds_read_b64_tr_b16 v[70:71], v11 offset:57600
    v_mfma_f32_32x32x16_bf16 v[148:163], v[56:59], v[24:27], v[148:163]
    ds_read_b64_tr_b16 v[72:73], v12 offset:56320
    ds_read_b64_tr_b16 v[74:75], v12 offset:57600
    s_waitcnt lgkmcnt(8)
    v_mfma_f32_32x32x16_bf16 v[164:179], v[60:63], v[20:23], v[164:179]
    s_waitcnt lgkmcnt(0)
    s_barrier
    v_mfma_f32_32x32x16_bf16 v[100:115], v[64:67], v[28:31], v[100:115]
    ds_read_b128 v[20:23], v2 offset:0
    ds_read_b64_tr_b16 v[52:53], v10 offset:0
    v_mfma_f32_32x32x16_bf16 v[116:131], v[64:67], v[32:35], v[116:131]
    ds_read_b64_tr_b16 v[54:55], v10 offset:1280
    ds_read_b128 v[24:27], v6 offset:0
    v_mfma_f32_32x32x16_bf16 v[132:147], v[68:71], v[28:31], v[132:147]
    ds_read_b64_tr_b16 v[56:57], v11 offset:0
    ds_read_b64_tr_b16 v[58:59], v11 offset:1280
    v_mfma_f32_32x32x16_bf16 v[148:163], v[68:71], v[32:35], v[148:163]
    ds_read_b64_tr_b16 v[60:61], v12 offset:0
    ds_read_b64_tr_b16 v[62:63], v12 offset:1280
    v_mfma_f32_32x32x16_bf16 v[164:179], v[72:75], v[28:31], v[164:179]
    s_waitcnt lgkmcnt(5)
    v_mfma_f32_32x32x16_bf16 v[100:115], v[52:55], v[20:23], v[100:115]
    ds_read_b128 v[28:31], v3 offset:0
    ds_read_b64_tr_b16 v[64:65], v10 offset:5120
    s_waitcnt lgkmcnt(6)
    v_mfma_f32_32x32x16_bf16 v[116:131], v[52:55], v[24:27], v[116:131]
    ds_read_b64_tr_b16 v[66:67], v10 offset:6400
    ds_read_b128 v[32:35], v7 offset:0
    s_waitcnt lgkmcnt(6)
    v_mfma_f32_32x32x16_bf16 v[132:147], v[56:59], v[20:23], v[132:147]
    ds_read_b64_tr_b16 v[68:69], v11 offset:5120
    ds_read_b64_tr_b16 v[70:71], v11 offset:6400
    v_mfma_f32_32x32x16_bf16 v[148:163], v[56:59], v[24:27], v[148:163]
    ds_read_b64_tr_b16 v[72:73], v12 offset:5120
    ds_read_b64_tr_b16 v[74:75], v12 offset:6400
    s_waitcnt lgkmcnt(8)
    v_mfma_f32_32x32x16_bf16 v[164:179], v[60:63], v[20:23], v[164:179]
    s_waitcnt lgkmcnt(5)
    v_mfma_f32_32x32x16_bf16 v[100:115], v[64:67], v[28:31], v[100:115]
    ds_read_b128 v[20:23], v4 offset:0
    ds_read_b64_tr_b16 v[52:53], v10 offset:10240
    s_waitcnt lgkmcnt(6)
    v_mfma_f32_32x32x16_bf16 v[116:131], v[64:67], v[32:35], v[116:131]
    ds_read_b64_tr_b16 v[54:55], v10 offset:11520
    ds_read_b128 v[24:27], v8 offset:0
    s_waitcnt lgkmcnt(6)
    v_mfma_f32_32x32x16_bf16 v[132:147], v[68:71], v[28:31], v[132:147]
    ds_read_b64_tr_b16 v[56:57], v11 offset:10240
    ds_read_b64_tr_b16 v[58:59], v11 offset:11520
    v_mfma_f32_32x32x16_bf16 v[148:163], v[68:71], v[32:35], v[148:163]
    ds_read_b64_tr_b16 v[60:61], v12 offset:10240
    ds_read_b64_tr_b16 v[62:63], v12 offset:11520
    s_waitcnt lgkmcnt(8)
    v_mfma_f32_32x32x16_bf16 v[164:179], v[72:75], v[28:31], v[164:179]
    s_waitcnt lgkmcnt(5)
    v_mfma_f32_32x32x16_bf16 v[100:115], v[52:55], v[20:23], v[100:115]
    ds_read_b128 v[28:31], v5 offset:0
    ds_read_b64_tr_b16 v[64:65], v10 offset:15360
    s_waitcnt lgkmcnt(6)
    v_mfma_f32_32x32x16_bf16 v[116:131], v[52:55], v[24:27], v[116:131]
    ds_read_b64_tr_b16 v[66:67], v10 offset:16640
    ds_read_b128 v[32:35], v9 offset:0
    s_waitcnt lgkmcnt(6)
    v_mfma_f32_32x32x16_bf16 v[132:147], v[56:59], v[20:23], v[132:147]
    ds_read_b64_tr_b16 v[68:69], v11 offset:15360
    ds_read_b64_tr_b16 v[70:71], v11 offset:16640
    v_mfma_f32_32x32x16_bf16 v[148:163], v[56:59], v[24:27], v[148:163]
    ds_read_b64_tr_b16 v[72:73], v12 offset:15360
    ds_read_b64_tr_b16 v[74:75], v12 offset:16640
    s_waitcnt lgkmcnt(8)
    v_mfma_f32_32x32x16_bf16 v[164:179], v[60:63], v[20:23], v[164:179]
    s_waitcnt lgkmcnt(0)
    s_barrier
    v_mfma_f32_32x32x16_bf16 v[100:115], v[64:67], v[28:31], v[100:115]
    ds_read_b128 v[20:23], v2 offset:16384
    ds_read_b64_tr_b16 v[52:53], v10 offset:20480
    v_mfma_f32_32x32x16_bf16 v[116:131], v[64:67], v[32:35], v[116:131]
    ds_read_b64_tr_b16 v[54:55], v10 offset:21760
    ds_read_b128 v[24:27], v6 offset:16384
    v_mfma_f32_32x32x16_bf16 v[132:147], v[68:71], v[28:31], v[132:147]
    ds_read_b64_tr_b16 v[56:57], v11 offset:20480
    ds_read_b64_tr_b16 v[58:59], v11 offset:21760
    v_mfma_f32_32x32x16_bf16 v[148:163], v[68:71], v[32:35], v[148:163]
    ds_read_b64_tr_b16 v[60:61], v12 offset:20480
    ds_read_b64_tr_b16 v[62:63], v12 offset:21760
    v_mfma_f32_32x32x16_bf16 v[164:179], v[72:75], v[28:31], v[164:179]
    s_waitcnt lgkmcnt(5)
    v_mfma_f32_32x32x16_bf16 v[100:115], v[52:55], v[20:23], v[100:115]
    ds_read_b128 v[28:31], v3 offset:16384
    ds_read_b64_tr_b16 v[64:65], v10 offset:25600
    s_waitcnt lgkmcnt(6)
    v_mfma_f32_32x32x16_bf16 v[116:131], v[52:55], v[24:27], v[116:131]
    ds_read_b64_tr_b16 v[66:67], v10 offset:26880
    ds_read_b128 v[32:35], v7 offset:16384
    s_waitcnt lgkmcnt(6)
    v_mfma_f32_32x32x16_bf16 v[132:147], v[56:59], v[20:23], v[132:147]
    ds_read_b64_tr_b16 v[68:69], v11 offset:25600
    ds_read_b64_tr_b16 v[70:71], v11 offset:26880
    v_mfma_f32_32x32x16_bf16 v[148:163], v[56:59], v[24:27], v[148:163]
    ds_read_b64_tr_b16 v[72:73], v12 offset:25600
    ds_read_b64_tr_b16 v[74:75], v12 offset:26880
    s_waitcnt lgkmcnt(8)
    v_mfma_f32_32x32x16_bf16 v[164:179], v[60:63], v[20:23], v[164:179]
    s_waitcnt lgkmcnt(5)
    v_mfma_f32_32x32x16_bf16 v[100:115], v[64:67], v[28:31], v[100:115]
    ds_read_b128 v[20:23], v4 offset:16384
    ds_read_b64_tr_b16 v[52:53], v10 offset:30720
    s_waitcnt lgkmcnt(6)
    v_mfma_f32_32x32x16_bf16 v[116:131], v[64:67], v[32:35], v[116:131]
    ds_read_b64_tr_b16 v[54:55], v10 offset:32000
    ds_read_b128 v[24:27], v8 offset:16384
    s_waitcnt lgkmcnt(6)
    v_mfma_f32_32x32x16_bf16 v[132:147], v[68:71], v[28:31], v[132:147]
    ds_read_b64_tr_b16 v[56:57], v11 offset:30720
    ds_read_b64_tr_b16 v[58:59], v11 offset:32000
    v_mfma_f32_32x32x16_bf16 v[148:163], v[68:71], v[32:35], v[148:163]
    ds_read_b64_tr_b16 v[60:61], v12 offset:30720
    ds_read_b64_tr_b16 v[62:63], v12 offset:32000
    s_waitcnt lgkmcnt(8)
    v_mfma_f32_32x32x16_bf16 v[164:179], v[72:75], v[28:31], v[164:179]
    s_waitcnt lgkmcnt(5)
    v_mfma_f32_32x32x16_bf16 v[100:115], v[52:55], v[20:23], v[100:115]
    ds_read_b128 v[28:31], v5 offset:16384
    ds_read_b64_tr_b16 v[64:65], v10 offset:35840
    s_waitcnt lgkmcnt(6)
    v_mfma_f32_32x32x16_bf16 v[116:131], v[52:55], v[24:27], v[116:131]
    ds_read_b64_tr_b16 v[66:67], v10 offset:37120
    ds_read_b128 v[32:35], v9 offset:16384
    s_waitcnt lgkmcnt(6)
    v_mfma_f32_32x32x16_bf16 v[132:147], v[56:59], v[20:23], v[132:147]
    ds_read_b64_tr_b16 v[68:69], v11 offset:35840
    ds_read_b64_tr_b16 v[70:71], v11 offset:37120
    v_mfma_f32_32x32x16_bf16 v[148:163], v[56:59], v[24:27], v[148:163]
    ds_read_b64_tr_b16 v[72:73], v12 offset:35840
    ds_read_b64_tr_b16 v[74:75], v12 offset:37120
    s_waitcnt lgkmcnt(8)
    v_mfma_f32_32x32x16_bf16 v[164:179], v[60:63], v[20:23], v[164:179]
    s_waitcnt lgkmcnt(0)
    s_barrier
    v_mfma_f32_32x32x16_bf16 v[100:115], v[64:67], v[28:31], v[100:115]
    ds_read_b128 v[20:23], v2 offset:32768
    ds_read_b64_tr_b16 v[52:53], v10 offset:40960
    v_mfma_f32_32x32x16_bf16 v[116:131], v[64:67], v[32:35], v[116:131]
    ds_read_b64_tr_b16 v[54:55], v10 offset:42240
    ds_read_b128 v[24:27], v6 offset:32768
    v_mfma_f32_32x32x16_bf16 v[132:147], v[68:71], v[28:31], v[132:147]
    ds_read_b64_tr_b16 v[56:57], v11 offset:40960
    ds_read_b64_tr_b16 v[58:59], v11 offset:42240
    v_mfma_f32_32x32x16_bf16 v[148:163], v[68:71], v[32:35], v[148:163]
    ds_read_b64_tr_b16 v[60:61], v12 offset:40960
    ds_read_b64_tr_b16 v[62:63], v12 offset:42240
    v_mfma_f32_32x32x16_bf16 v[164:179], v[72:75], v[28:31], v[164:179]
    s_waitcnt lgkmcnt(5)
    v_mfma_f32_32x32x16_bf16 v[100:115], v[52:55], v[20:23], v[100:115]
    ds_read_b128 v[28:31], v3 offset:32768
    ds_read_b64_tr_b16 v[64:65], v10 offset:46080
    s_waitcnt lgkmcnt(6)
    v_mfma_f32_32x32x16_bf16 v[116:131], v[52:55], v[24:27], v[116:131]
    ds_read_b64_tr_b16 v[66:67], v10 offset:47360
    ds_read_b128 v[32:35], v7 offset:32768
    s_waitcnt lgkmcnt(6)
    v_mfma_f32_32x32x16_bf16 v[132:147], v[56:59], v[20:23], v[132:147]
    ds_read_b64_tr_b16 v[68:69], v11 offset:46080
    ds_read_b64_tr_b16 v[70:71], v11 offset:47360
    v_mfma_f32_32x32x16_bf16 v[148:163], v[56:59], v[24:27], v[148:163]
    ds_read_b64_tr_b16 v[72:73], v12 offset:46080
    ds_read_b64_tr_b16 v[74:75], v12 offset:47360
    s_waitcnt lgkmcnt(8)
    v_mfma_f32_32x32x16_bf16 v[164:179], v[60:63], v[20:23], v[164:179]
    s_waitcnt lgkmcnt(5)
    v_mfma_f32_32x32x16_bf16 v[100:115], v[64:67], v[28:31], v[100:115]
    ds_read_b128 v[20:23], v4 offset:32768
    ds_read_b64_tr_b16 v[52:53], v10 offset:51200
    s_waitcnt lgkmcnt(6)
    v_mfma_f32_32x32x16_bf16 v[116:131], v[64:67], v[32:35], v[116:131]
    ds_read_b64_tr_b16 v[54:55], v10 offset:52480
    ds_read_b128 v[24:27], v8 offset:32768
    s_waitcnt lgkmcnt(6)
    v_mfma_f32_32x32x16_bf16 v[132:147], v[68:71], v[28:31], v[132:147]
    ds_read_b64_tr_b16 v[56:57], v11 offset:51200
    ds_read_b64_tr_b16 v[58:59], v11 offset:52480
    v_mfma_f32_32x32x16_bf16 v[148:163], v[68:71], v[32:35], v[148:163]
    ds_read_b64_tr_b16 v[60:61], v12 offset:51200
    ds_read_b64_tr_b16 v[62:63], v12 offset:52480
    s_waitcnt lgkmcnt(8)
    v_mfma_f32_32x32x16_bf16 v[164:179], v[72:75], v[28:31], v[164:179]
    s_waitcnt lgkmcnt(5)
    v_mfma_f32_32x32x16_bf16 v[100:115], v[52:55], v[20:23], v[100:115]
    ds_read_b128 v[28:31], v5 offset:32768
    ds_read_b64_tr_b16 v[64:65], v10 offset:56320
    s_waitcnt lgkmcnt(6)
    v_mfma_f32_32x32x16_bf16 v[116:131], v[52:55], v[24:27], v[116:131]
    ds_read_b64_tr_b16 v[66:67], v10 offset:57600
    ds_read_b128 v[32:35], v9 offset:32768
    s_waitcnt lgkmcnt(6)
    v_mfma_f32_32x32x16_bf16 v[132:147], v[56:59], v[20:23], v[132:147]
    ds_read_b64_tr_b16 v[68:69], v11 offset:56320
    ds_read_b64_tr_b16 v[70:71], v11 offset:57600
    v_mfma_f32_32x32x16_bf16 v[148:163], v[56:59], v[24:27], v[148:163]
    ds_read_b64_tr_b16 v[72:73], v12 offset:56320
    ds_read_b64_tr_b16 v[74:75], v12 offset:57600
    s_waitcnt lgkmcnt(8)
    v_mfma_f32_32x32x16_bf16 v[164:179], v[60:63], v[20:23], v[164:179]
    s_waitcnt lgkmcnt(0)
    s_barrier
    v_mfma_f32_32x32x16_bf16 v[100:115], v[64:67], v[28:31], v[100:115]
    ds_read_b128 v[20:23], v2 offset:0
    ds_read_b64_tr_b16 v[52:53], v10 offset:0
    v_mfma_f32_32x32x16_bf16 v[116:131], v[64:67], v[32:35], v[116:131]
    ds_read_b64_tr_b16 v[54:55], v10 offset:1280
    ds_read_b128 v[24:27], v6 offset:0
    v_mfma_f32_32x32x16_bf16 v[132:147], v[68:71], v[28:31], v[132:147]
    ds_read_b64_tr_b16 v[56:57], v11 offset:0
    ds_read_b64_tr_b16 v[58:59], v11 offset:1280
    v_mfma_f32_32x32x16_bf16 v[148:163], v[68:71], v[32:35], v[148:163]
    ds_read_b64_tr_b16 v[60:61], v12 offset:0
    ds_read_b64_tr_b16 v[62:63], v12 offset:1280
    v_mfma_f32_32x32x16_bf16 v[164:179], v[72:75], v[28:31], v[164:179]
    s_waitcnt lgkmcnt(5)
    v_mfma_f32_32x32x16_bf16 v[100:115], v[52:55], v[20:23], v[100:115]
    ds_read_b128 v[28:31], v3 offset:0
    ds_read_b64_tr_b16 v[64:65], v10 offset:5120
    s_waitcnt lgkmcnt(6)
    v_mfma_f32_32x32x16_bf16 v[116:131], v[52:55], v[24:27], v[116:131]
    ds_read_b64_tr_b16 v[66:67], v10 offset:6400
    ds_read_b128 v[32:35], v7 offset:0
    s_waitcnt lgkmcnt(6)
    v_mfma_f32_32x32x16_bf16 v[132:147], v[56:59], v[20:23], v[132:147]
    ds_read_b64_tr_b16 v[68:69], v11 offset:5120
    ds_read_b64_tr_b16 v[70:71], v11 offset:6400
    v_mfma_f32_32x32x16_bf16 v[148:163], v[56:59], v[24:27], v[148:163]
    ds_read_b64_tr_b16 v[72:73], v12 offset:5120
    ds_read_b64_tr_b16 v[74:75], v12 offset:6400
    s_waitcnt lgkmcnt(8)
    v_mfma_f32_32x32x16_bf16 v[164:179], v[60:63], v[20:23], v[164:179]
    s_waitcnt lgkmcnt(5)
    v_mfma_f32_32x32x16_bf16 v[100:115], v[64:67], v[28:31], v[100:115]
    ds_read_b128 v[20:23], v4 offset:0
    ds_read_b64_tr_b16 v[52:53], v10 offset:10240
    s_waitcnt lgkmcnt(6)
    v_mfma_f32_32x32x16_bf16 v[116:131], v[64:67], v[32:35], v[116:131]
    ds_read_b64_tr_b16 v[54:55], v10 offset:11520
    ds_read_b128 v[24:27], v8 offset:0
    s_waitcnt lgkmcnt(6)
    v_mfma_f32_32x32x16_bf16 v[132:147], v[68:71], v[28:31], v[132:147]
    ds_read_b64_tr_b16 v[56:57], v11 offset:10240
    ds_read_b64_tr_b16 v[58:59], v11 offset:11520
    v_mfma_f32_32x32x16_bf16 v[148:163], v[68:71], v[32:35], v[148:163]
    ds_read_b64_tr_b16 v[60:61], v12 offset:10240
    ds_read_b64_tr_b16 v[62:63], v12 offset:11520
    s_waitcnt lgkmcnt(8)
    v_mfma_f32_32x32x16_bf16 v[164:179], v[72:75], v[28:31], v[164:179]
    s_waitcnt lgkmcnt(5)
    v_mfma_f32_32x32x16_bf16 v[100:115], v[52:55], v[20:23], v[100:115]
    ds_read_b128 v[28:31], v5 offset:0
    ds_read_b64_tr_b16 v[64:65], v10 offset:15360
    s_waitcnt lgkmcnt(6)
    v_mfma_f32_32x32x16_bf16 v[116:131], v[52:55], v[24:27], v[116:131]
    ds_read_b64_tr_b16 v[66:67], v10 offset:16640
    ds_read_b128 v[32:35], v9 offset:0
    s_waitcnt lgkmcnt(6)
    v_mfma_f32_32x32x16_bf16 v[132:147], v[56:59], v[20:23], v[132:147]
    ds_read_b64_tr_b16 v[68:69], v11 offset:15360
    ds_read_b64_tr_b16 v[70:71], v11 offset:16640
    v_mfma_f32_32x32x16_bf16 v[148:163], v[56:59], v[24:27], v[148:163]
    ds_read_b64_tr_b16 v[72:73], v12 offset:15360
    ds_read_b64_tr_b16 v[74:75], v12 offset:16640
    s_waitcnt lgkmcnt(8)
    v_mfma_f32_32x32x16_bf16 v[164:179], v[60:63], v[20:23], v[164:179]
    s_waitcnt lgkmcnt(0)
    s_barrier
    v_mfma_f32_32x32x16_bf16 v[100:115], v[64:67], v[28:31], v[100:115]
    ds_read_b128 v[20:23], v2 offset:16384
    ds_read_b64_tr_b16 v[52:53], v10 offset:20480
    v_mfma_f32_32x32x16_bf16 v[116:131], v[64:67], v[32:35], v[116:131]
    ds_read_b64_tr_b16 v[54:55], v10 offset:21760
    ds_read_b128 v[24:27], v6 offset:16384
    v_mfma_f32_32x32x16_bf16 v[132:147], v[68:71], v[28:31], v[132:147]
    ds_read_b64_tr_b16 v[56:57], v11 offset:20480
    ds_read_b64_tr_b16 v[58:59], v11 offset:21760
    v_mfma_f32_32x32x16_bf16 v[148:163], v[68:71], v[32:35], v[148:163]
    ds_read_b64_tr_b16 v[60:61], v12 offset:20480
    ds_read_b64_tr_b16 v[62:63], v12 offset:21760
    v_mfma_f32_32x32x16_bf16 v[164:179], v[72:75], v[28:31], v[164:179]
    s_waitcnt lgkmcnt(5)
    v_mfma_f32_32x32x16_bf16 v[100:115], v[52:55], v[20:23], v[100:115]
    ds_read_b128 v[28:31], v3 offset:16384
    ds_read_b64_tr_b16 v[64:65], v10 offset:25600
    s_waitcnt lgkmcnt(6)
    v_mfma_f32_32x32x16_bf16 v[116:131], v[52:55], v[24:27], v[116:131]
    ds_read_b64_tr_b16 v[66:67], v10 offset:26880
    ds_read_b128 v[32:35], v7 offset:16384
    s_waitcnt lgkmcnt(6)
    v_mfma_f32_32x32x16_bf16 v[132:147], v[56:59], v[20:23], v[132:147]
    ds_read_b64_tr_b16 v[68:69], v11 offset:25600
    ds_read_b64_tr_b16 v[70:71], v11 offset:26880
    v_mfma_f32_32x32x16_bf16 v[148:163], v[56:59], v[24:27], v[148:163]
    ds_read_b64_tr_b16 v[72:73], v12 offset:25600
    ds_read_b64_tr_b16 v[74:75], v12 offset:26880
    s_waitcnt lgkmcnt(8)
    v_mfma_f32_32x32x16_bf16 v[164:179], v[60:63], v[20:23], v[164:179]
    s_waitcnt lgkmcnt(5)
    v_mfma_f32_32x32x16_bf16 v[100:115], v[64:67], v[28:31], v[100:115]
    ds_read_b128 v[20:23], v4 offset:16384
    ds_read_b64_tr_b16 v[52:53], v10 offset:30720
    s_waitcnt lgkmcnt(6)
    v_mfma_f32_32x32x16_bf16 v[116:131], v[64:67], v[32:35], v[116:131]
    ds_read_b64_tr_b16 v[54:55], v10 offset:32000
    ds_read_b128 v[24:27], v8 offset:16384
    s_waitcnt lgkmcnt(6)
    v_mfma_f32_32x32x16_bf16 v[132:147], v[68:71], v[28:31], v[132:147]
    ds_read_b64_tr_b16 v[56:57], v11 offset:30720
    ds_read_b64_tr_b16 v[58:59], v11 offset:32000
    v_mfma_f32_32x32x16_bf16 v[148:163], v[68:71], v[32:35], v[148:163]
    ds_read_b64_tr_b16 v[60:61], v12 offset:30720
    ds_read_b64_tr_b16 v[62:63], v12 offset:32000
    s_waitcnt lgkmcnt(8)
    v_mfma_f32_32x32x16_bf16 v[164:179], v[72:75], v[28:31], v[164:179]
    s_waitcnt lgkmcnt(5)
    v_mfma_f32_32x32x16_bf16 v[100:115], v[52:55], v[20:23], v[100:115]
    ds_read_b128 v[28:31], v5 offset:16384
    ds_read_b64_tr_b16 v[64:65], v10 offset:35840
    s_waitcnt lgkmcnt(6)
    v_mfma_f32_32x32x16_bf16 v[116:131], v[52:55], v[24:27], v[116:131]
    ds_read_b64_tr_b16 v[66:67], v10 offset:37120
    ds_read_b128 v[32:35], v9 offset:16384
    s_waitcnt lgkmcnt(6)
    v_mfma_f32_32x32x16_bf16 v[132:147], v[56:59], v[20:23], v[132:147]
    ds_read_b64_tr_b16 v[68:69], v11 offset:35840
    ds_read_b64_tr_b16 v[70:71], v11 offset:37120
    v_mfma_f32_32x32x16_bf16 v[148:163], v[56:59], v[24:27], v[148:163]
    ds_read_b64_tr_b16 v[72:73], v12 offset:35840
    ds_read_b64_tr_b16 v[74:75], v12 offset:37120
    s_waitcnt lgkmcnt(8)
    v_mfma_f32_32x32x16_bf16 v[164:179], v[60:63], v[20:23], v[164:179]
    s_waitcnt lgkmcnt(0)
    s_barrier
    v_mfma_f32_32x32x16_bf16 v[100:115], v[64:67], v[28:31], v[100:115]
    ds_read_b128 v[20:23], v2 offset:32768
    ds_read_b64_tr_b16 v[60:61], v12 offset:40960
    v_mfma_f32_32x32x16_bf16 v[116:131], v[64:67], v[32:35], v[116:131]
    ds_read_b64_tr_b16 v[62:63], v12 offset:42240
    ds_read_b128 v[36:39], v3 offset:32768
    v_mfma_f32_32x32x16_bf16 v[132:147], v[68:71], v[28:31], v[132:147]
    ds_read_b64_tr_b16 v[84:85], v12 offset:46080
    ds_read_b64_tr_b16 v[86:87], v12 offset:47360
    v_mfma_f32_32x32x16_bf16 v[148:163], v[68:71], v[32:35], v[148:163]
    ds_read_b128 v[44:47], v4 offset:32768
    ds_read_b64_tr_b16 v[96:97], v12 offset:51200
    v_mfma_f32_32x32x16_bf16 v[164:179], v[72:75], v[28:31], v[164:179]
    ds_read_b64_tr_b16 v[98:99], v12 offset:52480
    ds_read_b128 v[28:31], v5 offset:32768
    ds_read_b64_tr_b16 v[72:73], v12 offset:56320
    s_waitcnt lgkmcnt(8)
    v_mfma_f32_32x32x16_bf16 v[164:179], v[60:63], v[20:23], v[164:179]
    ds_read_b64_tr_b16 v[74:75], v12 offset:57600
    ds_read_b64_tr_b16 v[52:53], v10 offset:40960
    s_waitcnt lgkmcnt(7)
    v_mfma_f32_32x32x16_bf16 v[164:179], v[84:87], v[36:39], v[164:179]
    ds_read_b64_tr_b16 v[54:55], v10 offset:42240
    ds_read_b64_tr_b16 v[76:77], v10 offset:46080
    s_waitcnt lgkmcnt(6)
    v_mfma_f32_32x32x16_bf16 v[164:179], v[96:99], v[44:47], v[164:179]
    ds_read_b64_tr_b16 v[78:79], v10 offset:47360
    ds_read_b64_tr_b16 v[88:89], v10 offset:51200
    s_waitcnt lgkmcnt(5)
    v_mfma_f32_32x32x16_bf16 v[164:179], v[72:75], v[28:31], v[164:179]
    ds_read_b64_tr_b16 v[90:91], v10 offset:52480
    ds_read_b64_tr_b16 v[64:65], v10 offset:56320
    s_waitcnt lgkmcnt(5)
    v_mfma_f32_32x32x16_bf16 v[100:115], v[52:55], v[20:23], v[100:115]
    ds_read_b64_tr_b16 v[66:67], v10 offset:57600
    ds_read_b128 v[24:27], v6 offset:32768
    s_waitcnt lgkmcnt(5)
    v_mfma_f32_32x32x16_bf16 v[100:115], v[76:79], v[36:39], v[100:115]
    ds_read_b128 v[40:43], v7 offset:32768
    ds_read_b128 v[48:51], v8 offset:32768
    s_waitcnt lgkmcnt(5)
    v_mfma_f32_32x32x16_bf16 v[100:115], v[88:91], v[44:47], v[100:115]
    ds_read_b128 v[32:35], v9 offset:32768
    ds_read_b64_tr_b16 v[56:57], v11 offset:40960
    v_mul_f32 v164, s76, v164
    v_mul_f32 v165, s76, v165
    v_mul_f32 v166, s76, v166
    v_mul_f32 v167, s76, v167
    v_mul_f32 v168, s76, v168
    v_mul_f32 v169, s76, v169
    v_mul_f32 v170, s76, v170
    s_waitcnt lgkmcnt(5)
    v_mfma_f32_32x32x16_bf16 v[100:115], v[64:67], v[28:31], v[100:115]
    ds_read_b64_tr_b16 v[58:59], v11 offset:42240
    ds_read_b64_tr_b16 v[80:81], v11 offset:46080
    v_mul_f32 v171, s76, v171
    v_cvt_pk_bf16_f32 v172, v164, v165
    v_cvt_pk_bf16_f32 v173, v166, v167
    v_cvt_pk_bf16_f32 v174, v168, v169
    v_cvt_pk_bf16_f32 v175, v170, v171
    ds_write_b32 v181, v172 offset:0
    ds_write_b32 v181, v173 offset:512
    s_waitcnt lgkmcnt(8)
    v_mfma_f32_32x32x16_bf16 v[116:131], v[52:55], v[24:27], v[116:131]
    ds_read_b64_tr_b16 v[82:83], v11 offset:47360
    ds_read_b64_tr_b16 v[92:93], v11 offset:51200
    ds_write_b32 v181, v174 offset:2048
    ds_write_b32 v181, v175 offset:2560
    v_mul_f32 v100, s76, v100
    v_mul_f32 v101, s76, v101
    v_mul_f32 v102, s76, v102
    v_mul_f32 v103, s76, v103
    v_mul_f32 v104, s76, v104
    s_waitcnt lgkmcnt(11)
    v_mfma_f32_32x32x16_bf16 v[116:131], v[76:79], v[40:43], v[116:131]
    ds_read_b64_tr_b16 v[94:95], v11 offset:52480
    ds_read_b64_tr_b16 v[68:69], v11 offset:56320
    v_mul_f32 v105, s76, v105
    v_mul_f32 v106, s76, v106
    v_mul_f32 v107, s76, v107
    v_cvt_pk_bf16_f32 v100, v100, v101
    v_cvt_pk_bf16_f32 v101, v102, v103
    v_cvt_pk_bf16_f32 v102, v104, v105
    v_cvt_pk_bf16_f32 v103, v106, v107
    s_waitcnt lgkmcnt(12)
    v_mfma_f32_32x32x16_bf16 v[116:131], v[88:91], v[48:51], v[116:131]
    ds_read_b64_tr_b16 v[70:71], v11 offset:57600
    buffer_store_dwordx4 v[100:103], v180, s[16:19], s64 offen sc1
    v_mul_f32 v108, s76, v108
    v_mul_f32 v109, s76, v109
    v_mul_f32 v110, s76, v110
    v_mul_f32 v111, s76, v111
    v_mul_f32 v112, s76, v112
    v_mul_f32 v113, s76, v113
    s_waitcnt lgkmcnt(12)
    v_mfma_f32_32x32x16_bf16 v[116:131], v[64:67], v[32:35], v[116:131]
    v_mul_f32 v114, s76, v114
    v_mul_f32 v115, s76, v115
    v_cvt_pk_bf16_f32 v108, v108, v109
    v_cvt_pk_bf16_f32 v109, v110, v111
    v_cvt_pk_bf16_f32 v110, v112, v113
    v_cvt_pk_bf16_f32 v111, v114, v115
    buffer_store_dwordx4 v[108:111], v180, s[16:19], s65 offen sc1
    s_waitcnt lgkmcnt(10)
    v_mfma_f32_32x32x16_bf16 v[132:147], v[56:59], v[20:23], v[132:147]
    s_waitcnt lgkmcnt(6)
    v_mfma_f32_32x32x16_bf16 v[132:147], v[80:83], v[36:39], v[132:147]
    s_waitcnt lgkmcnt(2)
    v_mfma_f32_32x32x16_bf16 v[132:147], v[92:95], v[44:47], v[132:147]
    v_mul_f32 v116, s76, v116
    v_mul_f32 v117, s76, v117
    v_mul_f32 v118, s76, v118
    v_mul_f32 v119, s76, v119
    v_mul_f32 v120, s76, v120
    v_mul_f32 v121, s76, v121
    v_mul_f32 v122, s76, v122
    s_waitcnt lgkmcnt(0)
    v_mfma_f32_32x32x16_bf16 v[132:147], v[68:71], v[28:31], v[132:147]
    v_mul_f32 v123, s76, v123
    v_cvt_pk_bf16_f32 v116, v116, v117
    v_cvt_pk_bf16_f32 v117, v118, v119
    v_cvt_pk_bf16_f32 v118, v120, v121
    v_cvt_pk_bf16_f32 v119, v122, v123
    buffer_store_dwordx4 v[116:119], v182, s[16:19], s64 offen sc1
    v_mul_f32 v124, s76, v124
    s_waitcnt lgkmcnt(0)
    s_barrier
    v_mfma_f32_32x32x16_bf16 v[148:163], v[56:59], v[24:27], v[148:163]
    v_mul_f32 v125, s76, v125
    v_mul_f32 v126, s76, v126
    v_mul_f32 v127, s76, v127
    v_mul_f32 v128, s76, v128
    v_mul_f32 v129, s76, v129
    v_mul_f32 v130, s76, v130
    v_mul_f32 v131, s76, v131
    v_mfma_f32_32x32x16_bf16 v[148:163], v[80:83], v[40:43], v[148:163]
    v_cvt_pk_bf16_f32 v124, v124, v125
    v_cvt_pk_bf16_f32 v125, v126, v127
    v_cvt_pk_bf16_f32 v126, v128, v129
    v_cvt_pk_bf16_f32 v127, v130, v131
    buffer_store_dwordx4 v[124:127], v182, s[16:19], s65 offen sc1
    v_mul_f32 v132, s76, v132
    v_mul_f32 v133, s76, v133
    v_mfma_f32_32x32x16_bf16 v[148:163], v[92:95], v[48:51], v[148:163]
    v_mul_f32 v134, s76, v134
    v_mul_f32 v135, s76, v135
    v_mul_f32 v136, s76, v136
    v_mul_f32 v137, s76, v137
    v_mul_f32 v138, s76, v138
    v_mul_f32 v139, s76, v139
    v_cvt_pk_bf16_f32 v132, v132, v133
    v_mfma_f32_32x32x16_bf16 v[148:163], v[68:71], v[32:35], v[148:163]
    v_cvt_pk_bf16_f32 v133, v134, v135
    v_cvt_pk_bf16_f32 v134, v136, v137
    v_cvt_pk_bf16_f32 v135, v138, v139
    buffer_store_dwordx4 v[132:135], v180, s[16:19], s66 offen sc1
    v_mul_f32 v140, s76, v140
    v_mul_f32 v141, s76, v141
    v_mul_f32 v142, s76, v142
    v_mul_f32 v143, s76, v143
    v_mul_f32 v144, s76, v144
    v_mul_f32 v145, s76, v145
    v_mul_f32 v146, s76, v146
    v_mul_f32 v147, s76, v147
    v_cvt_pk_bf16_f32 v140, v140, v141
    v_cvt_pk_bf16_f32 v141, v142, v143
    v_cvt_pk_bf16_f32 v142, v144, v145
    v_cvt_pk_bf16_f32 v143, v146, v147
    buffer_store_dwordx4 v[140:143], v180, s[16:19], s67 offen sc1
    v_mul_f32 v148, s76, v148
    v_mul_f32 v149, s76, v149
    v_mul_f32 v150, s76, v150
    v_mul_f32 v151, s76, v151
    v_mul_f32 v152, s76, v152
    v_mul_f32 v153, s76, v153
    v_mul_f32 v154, s76, v154
    v_mul_f32 v155, s76, v155
    v_cvt_pk_bf16_f32 v148, v148, v149
    v_cvt_pk_bf16_f32 v149, v150, v151
    v_cvt_pk_bf16_f32 v150, v152, v153
    v_cvt_pk_bf16_f32 v151, v154, v155
    buffer_store_dwordx4 v[148:151], v182, s[16:19], s66 offen sc1
    v_mul_f32 v156, s76, v156
    v_mul_f32 v157, s76, v157
    v_mul_f32 v158, s76, v158
    v_mul_f32 v159, s76, v159
    v_mul_f32 v160, s76, v160
    v_mul_f32 v161, s76, v161
    v_mul_f32 v162, s76, v162
    v_mul_f32 v163, s76, v163
    v_cvt_pk_bf16_f32 v156, v156, v157
    v_cvt_pk_bf16_f32 v157, v158, v159
    v_cvt_pk_bf16_f32 v158, v160, v161
    v_cvt_pk_bf16_f32 v159, v162, v163
    buffer_store_dwordx4 v[156:159], v182, s[16:19], s67 offen sc1
    s_branch L_join
L_v_4:
    s_lshr_b32 s69, s3, 1
    s_and_b32 s70, s3, 1
    v_and_b32 v13, 31, v1
    v_lshrrev_b32 v14, 5, v1
    v_bfe_u32 v15, v1, 1, 3
    v_xor_b32 v15, v15, v14
    s_lshl_b32 s71, s3, 12
    v_lshlrev_b32 v13, 7, v13
    v_lshl_add_u32 v13, v15, 4, v13
    v_add_u32 v2, s71, v13
    v_xor_b32 v3, 32, v2
    v_xor_b32 v4, 64, v2
    v_xor_b32 v5, 0x60, v2
    v_xor_b32 v6, 0x1000, v2
    v_xor_b32 v7, 0x1000, v3
    v_xor_b32 v8, 0x1000, v4
    v_xor_b32 v9, 0x1000, v5
    v_bfe_u32 v13, v1, 2, 2
    v_lshl_add_u32 v13, v14, 3, v13
    v_mul_u32_u24 v13, 320, v13
    v_add_u32 v13, 49152, v13
    v_and_b32 v15, 3, v1
    v_bfe_u32 v16, v1, 4, 1
    v_lshl_add_u32 v14, v15, 3, v13
    v_lshl_add_u32 v13, v16, 5, v14
    s_cmp_eq_u32 s70, 0
    s_cselect_b32 s71, 256, 0
    s_cselect_b32 s78, 0, 112
    s_cselect_b32 s79, 40, 184
    v_mul_u32_u24 v10, s71, v16
    v_add3_u32 v10, v10, v13, s78
    v_add_u32 v11, s79, v13
    v_lshl_add_u32 v15, v15, 6, 32
    v_xor_b32 v16, 1, v16
    v_mul_u32_u24 v15, v15, v16
    v_add_u32 v12, v15, v14
    s_cmp_eq_u32 s70, 0
    s_cselect_b32 s64, 0, 3
    s_cselect_b32 s65, 7, 1
    s_cselect_b32 s66, 1, 5
    s_mul_i32 s64, s64, s74
    s_mul_i32 s65, s65, s74
    s_mul_i32 s66, s66, s74
    s_mul_i32 s71, s3, 1216
    s_add_u32 s64, s64, s71
    s_add_u32 s66, s66, s71
    v_and_b32 v13, 15, v1
    v_lshrrev_b32 v14, 5, v1
    v_lshlrev_b32 v13, 4, v13
    v_lshl_add_u32 v13, v14, 8, v13
    v_bfe_u32 v16, v1, 4, 1
    v_mul_lo_u32 v15, v16, s65
    v_add3_u32 v180, v15, v13, s64
    v_mul_lo_u32 v15, v16, s74
    v_add3_u32 v181, v15, v13, s66
    s_mul_i32 s64, s70, -2432
    s_add_u32 s64, s64, 1216
    s_add_u32 s64, s64, s73
    v_and_b32 v13, 31, v1
    v_mul_u32_u24 v14, 48, v14
    s_mul_i32 s71, s3, 192
    s_add_u32 s71, s71, 49152
    v_add_u32 v14, s71, v14
    v_lshrrev_b32 v15, 1, v13
    v_mul_u32_u24 v15, 768, v15
    v_and_b32 v16, 1, v1
    v_lshl_add_u32 v15, v16, 4, v15
    v_add_u32 v182, v15, v14
    v_subrev_u32 v15, 16, v13
    v_mul_u32_u24 v15, 768, v15
    v_add3_u32 v15, v15, v14, 32
    v_cmp_le_u32 s[76:77], 16, v13
    v_cmp_le_u32 s[78:79], 24, v13
    v_mov_b32 v16, 0x100000
    v_cndmask_b32 v182, v182, v15, s[76:77]
    v_cndmask_b32 v182, v182, v16, s[78:79]
    v_mov_b32 v16, 0x3f803f80
    s_waitcnt vmcnt(0)
    s_mov_b32 s100, 1
    s_branch L_kb_8
L_kbr_10:
    s_barrier
    ds_read_b128 v[20:23], v2 offset:0
    ds_read_b64_tr_b16 v[52:53], v10 offset:0
    ds_read_b64_tr_b16 v[54:55], v10 offset:1280
    ds_read_b128 v[24:27], v6 offset:0
    ds_read_b64_tr_b16 v[56:57], v11 offset:0
    ds_read_b64_tr_b16 v[58:59], v11 offset:1280
    ds_read_b64_tr_b16 v[60:61], v12 offset:0
    ds_read_b64_tr_b16 v[62:63], v12 offset:1280
    s_waitcnt lgkmcnt(5)
    v_mfma_f32_32x32x16_bf16 v[100:115], v[20:23], v[52:55], 0
    ds_read_b128 v[28:31], v3 offset:0
    ds_read_b64_tr_b16 v[64:65], v10 offset:5120
    s_waitcnt lgkmcnt(6)
    v_mfma_f32_32x32x16_bf16 v[116:131], v[24:27], v[52:55], 0
    ds_read_b64_tr_b16 v[66:67], v10 offset:6400
    ds_read_b128 v[32:35], v7 offset:0
    s_waitcnt lgkmcnt(6)
    v_mfma_f32_32x32x16_bf16 v[132:147], v[20:23], v[56:59], 0
    ds_read_b64_tr_b16 v[68:69], v11 offset:5120
    ds_read_b64_tr_b16 v[70:71], v11 offset:6400
    v_mfma_f32_32x32x16_bf16 v[148:163], v[24:27], v[56:59], 0
    ds_read_b64_tr_b16 v[72:73], v12 offset:5120
    ds_read_b64_tr_b16 v[74:75], v12 offset:6400
    s_waitcnt lgkmcnt(8)
    v_mfma_f32_32x32x16_bf16 v[164:179], v[20:23], v[60:63], 0
    s_waitcnt lgkmcnt(5)
    v_mfma_f32_32x32x16_bf16 v[100:115], v[28:31], v[64:67], v[100:115]
    ds_read_b128 v[20:23], v4 offset:0
    ds_read_b64_tr_b16 v[52:53], v10 offset:10240
    s_waitcnt lgkmcnt(6)
    v_mfma_f32_32x32x16_bf16 v[116:131], v[32:35], v[64:67], v[116:131]
    ds_read_b64_tr_b16 v[54:55], v10 offset:11520
    ds_read_b128 v[24:27], v8 offset:0
    s_waitcnt lgkmcnt(6)
    v_mfma_f32_32x32x16_bf16 v[132:147], v[28:31], v[68:71], v[132:147]
    ds_read_b64_tr_b16 v[56:57], v11 offset:10240
    ds_read_b64_tr_b16 v[58:59], v11 offset:11520
    v_mfma_f32_32x32x16_bf16 v[148:163], v[32:35], v[68:71], v[148:163]
    ds_read_b64_tr_b16 v[60:61], v12 offset:10240
    ds_read_b64_tr_b16 v[62:63], v12 offset:11520
    s_waitcnt lgkmcnt(8)
    v_mfma_f32_32x32x16_bf16 v[164:179], v[28:31], v[72:75], v[164:179]
    s_waitcnt lgkmcnt(5)
    v_mfma_f32_32x32x16_bf16 v[100:115], v[20:23], v[52:55], v[100:115]
    ds_read_b128 v[28:31], v5 offset:0
    ds_read_b64_tr_b16 v[64:65], v10 offset:15360
    s_waitcnt lgkmcnt(6)
    v_mfma_f32_32x32x16_bf16 v[116:131], v[24:27], v[52:55], v[116:131]
    ds_read_b64_tr_b16 v[66:67], v10 offset:16640
    ds_read_b128 v[32:35], v9 offset:0
    s_waitcnt lgkmcnt(6)
    v_mfma_f32_32x32x16_bf16 v[132:147], v[20:23], v[56:59], v[132:147]
    ds_read_b64_tr_b16 v[68:69], v11 offset:15360
    ds_read_b64_tr_b16 v[70:71], v11 offset:16640
    v_mfma_f32_32x32x16_bf16 v[148:163], v[24:27], v[56:59], v[148:163]
    ds_read_b64_tr_b16 v[72:73], v12 offset:15360
    ds_read_b64_tr_b16 v[74:75], v12 offset:16640
    s_waitcnt lgkmcnt(8)
    v_mfma_f32_32x32x16_bf16 v[164:179], v[20:23], v[60:63], v[164:179]
    s_waitcnt lgkmcnt(0)
    s_barrier
    v_mfma_f32_32x32x16_bf16 v[100:115], v[28:31], v[64:67], v[100:115]
    ds_read_b128 v[20:23], v2 offset:16384
    ds_read_b64_tr_b16 v[52:53], v10 offset:20480
    v_mfma_f32_32x32x16_bf16 v[116:131], v[32:35], v[64:67], v[116:131]
    ds_read_b64_tr_b16 v[54:55], v10 offset:21760
    ds_read_b128 v[24:27], v6 offset:16384
    v_mfma_f32_32x32x16_bf16 v[132:147], v[28:31], v[68:71], v[132:147]
    ds_read_b64_tr_b16 v[56:57], v11 offset:20480
    ds_read_b64_tr_b16 v[58:59], v11 offset:21760
    v_mfma_f32_32x32x16_bf16 v[148:163], v[32:35], v[68:71], v[148:163]
    ds_read_b64_tr_b16 v[60:61], v12 offset:20480
    ds_read_b64_tr_b16 v[62:63], v12 offset:21760
    v_mfma_f32_32x32x16_bf16 v[164:179], v[28:31], v[72:75], v[164:179]
    s_waitcnt lgkmcnt(5)
    v_mfma_f32_32x32x16_bf16 v[100:115], v[20:23], v[52:55], v[100:115]
    ds_read_b128 v[28:31], v3 offset:16384
    ds_read_b64_tr_b16 v[64:65], v10 offset:25600
    s_waitcnt lgkmcnt(6)
    v_mfma_f32_32x32x16_bf16 v[116:131], v[24:27], v[52:55], v[116:131]
    ds_read_b64_tr_b16 v[66:67], v10 offset:26880
    ds_read_b128 v[32:35], v7 offset:16384
    s_waitcnt lgkmcnt(6)
    v_mfma_f32_32x32x16_bf16 v[132:147], v[20:23], v[56:59], v[132:147]
    ds_read_b64_tr_b16 v[68:69], v11 offset:25600
    ds_read_b64_tr_b16 v[70:71], v11 offset:26880
    v_mfma_f32_32x32x16_bf16 v[148:163], v[24:27], v[56:59], v[148:163]
    ds_read_b64_tr_b16 v[72:73], v12 offset:25600
    ds_read_b64_tr_b16 v[74:75], v12 offset:26880
    s_waitcnt lgkmcnt(8)
    v_mfma_f32_32x32x16_bf16 v[164:179], v[20:23], v[60:63], v[164:179]
    s_waitcnt lgkmcnt(5)
    v_mfma_f32_32x32x16_bf16 v[100:115], v[28:31], v[64:67], v[100:115]
    ds_read_b128 v[20:23], v4 offset:16384
    ds_read_b64_tr_b16 v[52:53], v10 offset:30720
    s_waitcnt lgkmcnt(6)
    v_mfma_f32_32x32x16_bf16 v[116:131], v[32:35], v[64:67], v[116:131]
    ds_read_b64_tr_b16 v[54:55], v10 offset:32000
    ds_read_b128 v[24:27], v8 offset:16384
    s_waitcnt lgkmcnt(6)
    v_mfma_f32_32x32x16_bf16 v[132:147], v[28:31], v[68:71], v[132:147]
    ds_read_b64_tr_b16 v[56:57], v11 offset:30720
    ds_read_b64_tr_b16 v[58:59], v11 offset:32000
    v_mfma_f32_32x32x16_bf16 v[148:163], v[32:35], v[68:71], v[148:163]
    ds_read_b64_tr_b16 v[60:61], v12 offset:30720
    ds_read_b64_tr_b16 v[62:63], v12 offset:32000
    s_waitcnt lgkmcnt(8)
    v_mfma_f32_32x32x16_bf16 v[164:179], v[28:31], v[72:75], v[164:179]
    s_waitcnt lgkmcnt(5)
    v_mfma_f32_32x32x16_bf16 v[100:115], v[20:23], v[52:55], v[100:115]
    ds_read_b128 v[28:31], v5 offset:16384
    ds_read_b64_tr_b16 v[64:65], v10 offset:35840
    s_waitcnt lgkmcnt(6)
    v_mfma_f32_32x32x16_bf16 v[116:131], v[24:27], v[52:55], v[116:131]
    ds_read_b64_tr_b16 v[66:67], v10 offset:37120
    ds_read_b128 v[32:35], v9 offset:16384
    s_waitcnt lgkmcnt(6)
    v_mfma_f32_32x32x16_bf16 v[132:147], v[20:23], v[56:59], v[132:147]
    ds_read_b64_tr_b16 v[68:69], v11 offset:35840
    ds_read_b64_tr_b16 v[70:71], v11 offset:37120
    v_mfma_f32_32x32x16_bf16 v[148:163], v[24:27], v[56:59], v[148:163]
    ds_read_b64_tr_b16 v[72:73], v12 offset:35840
    ds_read_b64_tr_b16 v[74:75], v12 offset:37120
    s_waitcnt lgkmcnt(8)
    v_mfma_f32_32x32x16_bf16 v[164:179], v[20:23], v[60:63], v[164:179]
    s_waitcnt lgkmcnt(0)
    s_barrier
    v_mfma_f32_32x32x16_bf16 v[100:115], v[28:31], v[64:67], v[100:115]
    ds_read_b128 v[20:23], v2 offset:32768
    ds_read_b64_tr_b16 v[52:53], v10 offset:40960
    v_mfma_f32_32x32x16_bf16 v[116:131], v[32:35], v[64:67], v[116:131]
    ds_read_b64_tr_b16 v[54:55], v10 offset:42240
    ds_read_b128 v[24:27], v6 offset:32768
    v_mfma_f32_32x32x16_bf16 v[132:147], v[28:31], v[68:71], v[132:147]
    ds_read_b64_tr_b16 v[56:57], v11 offset:40960
    ds_read_b64_tr_b16 v[58:59], v11 offset:42240
    v_mfma_f32_32x32x16_bf16 v[148:163], v[32:35], v[68:71], v[148:163]
    ds_read_b64_tr_b16 v[60:61], v12 offset:40960
    ds_read_b64_tr_b16 v[62:63], v12 offset:42240
    v_mfma_f32_32x32x16_bf16 v[164:179], v[28:31], v[72:75], v[164:179]
    s_waitcnt lgkmcnt(5)
    v_mfma_f32_32x32x16_bf16 v[100:115], v[20:23], v[52:55], v[100:115]
    ds_read_b128 v[28:31], v3 offset:32768
    ds_read_b64_tr_b16 v[64:65], v10 offset:46080
    s_waitcnt lgkmcnt(6)
    v_mfma_f32_32x32x16_bf16 v[116:131], v[24:27], v[52:55], v[116:131]
    ds_read_b64_tr_b16 v[66:67], v10 offset:47360
    ds_read_b128 v[32:35], v7 offset:32768
    s_waitcnt lgkmcnt(6)
    v_mfma_f32_32x32x16_bf16 v[132:147], v[20:23], v[56:59], v[132:147]
    ds_read_b64_tr_b16 v[68:69], v11 offset:46080
    ds_read_b64_tr_b16 v[70:71], v11 offset:47360
    v_mfma_f32_32x32x16_bf16 v[148:163], v[24:27], v[56:59], v[148:163]
    ds_read_b64_tr_b16 v[72:73], v12 offset:46080
    ds_read_b64_tr_b16 v[74:75], v12 offset:47360
    s_waitcnt lgkmcnt(8)
    v_mfma_f32_32x32x16_bf16 v[164:179], v[20:23], v[60:63], v[164:179]
    s_waitcnt lgkmcnt(5)
    v_mfma_f32_32x32x16_bf16 v[100:115], v[28:31], v[64:67], v[100:115]
    ds_read_b128 v[20:23], v4 offset:32768
    ds_read_b64_tr_b16 v[52:53], v10 offset:51200
    s_waitcnt lgkmcnt(6)
    v_mfma_f32_32x32x16_bf16 v[116:131], v[32:35], v[64:67], v[116:131]
    ds_read_b64_tr_b16 v[54:55], v10 offset:52480
    ds_read_b128 v[24:27], v8 offset:32768
    s_waitcnt lgkmcnt(6)
    v_mfma_f32_32x32x16_bf16 v[132:147], v[28:31], v[68:71], v[132:147]
    ds_read_b64_tr_b16 v[56:57], v11 offset:51200
    ds_read_b64_tr_b16 v[58:59], v11 offset:52480
    v_mfma_f32_32x32x16_bf16 v[148:163], v[32:35], v[68:71], v[148:163]
    ds_read_b64_tr_b16 v[60:61], v12 offset:51200
    ds_read_b64_tr_b16 v[62:63], v12 offset:52480
    s_waitcnt lgkmcnt(8)
    v_mfma_f32_32x32x16_bf16 v[164:179], v[28:31], v[72:75], v[164:179]
    s_waitcnt lgkmcnt(5)
    v_mfma_f32_32x32x16_bf16 v[100:115], v[20:23], v[52:55], v[100:115]
    ds_read_b128 v[28:31], v5 offset:32768
    ds_read_b64_tr_b16 v[64:65], v10 offset:56320
    s_waitcnt lgkmcnt(6)
    v_mfma_f32_32x32x16_bf16 v[116:131], v[24:27], v[52:55], v[116:131]
    ds_read_b64_tr_b16 v[66:67], v10 offset:57600
    ds_read_b128 v[32:35], v9 offset:32768
    s_waitcnt lgkmcnt(6)
    v_mfma_f32_32x32x16_bf16 v[132:147], v[20:23], v[56:59], v[132:147]
    ds_read_b64_tr_b16 v[68:69], v11 offset:56320
    ds_read_b64_tr_b16 v[70:71], v11 offset:57600
    v_mfma_f32_32x32x16_bf16 v[148:163], v[24:27], v[56:59], v[148:163]
    ds_read_b64_tr_b16 v[72:73], v12 offset:56320
    ds_read_b64_tr_b16 v[74:75], v12 offset:57600
    s_waitcnt lgkmcnt(8)
    v_mfma_f32_32x32x16_bf16 v[164:179], v[20:23], v[60:63], v[164:179]
    s_waitcnt lgkmcnt(0)
    s_barrier
    v_mfma_f32_32x32x16_bf16 v[100:115], v[28:31], v[64:67], v[100:115]
    ds_read_b128 v[20:23], v2 offset:0
    ds_read_b64_tr_b16 v[52:53], v10 offset:0
    v_mfma_f32_32x32x16_bf16 v[116:131], v[32:35], v[64:67], v[116:131]
    ds_read_b64_tr_b16 v[54:55], v10 offset:1280
    ds_read_b128 v[24:27], v6 offset:0
    v_mfma_f32_32x32x16_bf16 v[132:147], v[28:31], v[68:71], v[132:147]
    ds_read_b64_tr_b16 v[56:57], v11 offset:0
    ds_read_b64_tr_b16 v[58:59], v11 offset:1280
    v_mfma_f32_32x32x16_bf16 v[148:163], v[32:35], v[68:71], v[148:163]
    ds_read_b64_tr_b16 v[60:61], v12 offset:0
    ds_read_b64_tr_b16 v[62:63], v12 offset:1280
    v_mfma_f32_32x32x16_bf16 v[164:179], v[28:31], v[72:75], v[164:179]
    s_waitcnt lgkmcnt(5)
    v_mfma_f32_32x32x16_bf16 v[100:115], v[20:23], v[52:55], v[100:115]
    ds_read_b128 v[28:31], v3 offset:0
    ds_read_b64_tr_b16 v[64:65], v10 offset:5120
    s_waitcnt lgkmcnt(6)
    v_mfma_f32_32x32x16_bf16 v[116:131], v[24:27], v[52:55], v[116:131]
    ds_read_b64_tr_b16 v[66:67], v10 offset:6400
    ds_read_b128 v[32:35], v7 offset:0
    s_waitcnt lgkmcnt(6)
    v_mfma_f32_32x32x16_bf16 v[132:147], v[20:23], v[56:59], v[132:147]
    ds_read_b64_tr_b16 v[68:69], v11 offset:5120
    ds_read_b64_tr_b16 v[70:71], v11 offset:6400
    v_mfma_f32_32x32x16_bf16 v[148:163], v[24:27], v[56:59], v[148:163]
    ds_read_b64_tr_b16 v[72:73], v12 offset:5120
    ds_read_b64_tr_b16 v[74:75], v12 offset:6400
    s_waitcnt lgkmcnt(8)
    v_mfma_f32_32x32x16_bf16 v[164:179], v[20:23], v[60:63], v[164:179]
    s_waitcnt lgkmcnt(5)
    v_mfma_f32_32x32x16_bf16 v[100:115], v[28:31], v[64:67], v[100:115]
    ds_read_b128 v[20:23], v4 offset:0
    ds_read_b64_tr_b16 v[52:53], v10 offset:10240
    s_waitcnt lgkmcnt(6)
    v_mfma_f32_32x32x16_bf16 v[116:131], v[32:35], v[64:67], v[116:131]
    ds_read_b64_tr_b16 v[54:55], v10 offset:11520
    ds_read_b128 v[24:27], v8 offset:0
    s_waitcnt lgkmcnt(6)
    v_mfma_f32_32x32x16_bf16 v[132:147], v[28:31], v[68:71], v[132:147]
    ds_read_b64_tr_b16 v[56:57], v11 offset:10240
    ds_read_b64_tr_b16 v[58:59], v11 offset:11520
    v_mfma_f32_32x32x16_bf16 v[148:163], v[32:35], v[68:71], v[148:163]
    ds_read_b64_tr_b16 v[60:61], v12 offset:10240
    ds_read_b64_tr_b16 v[62:63], v12 offset:11520
    s_waitcnt lgkmcnt(8)
    v_mfma_f32_32x32x16_bf16 v[164:179], v[28:31], v[72:75], v[164:179]
    s_waitcnt lgkmcnt(5)
    v_mfma_f32_32x32x16_bf16 v[100:115], v[20:23], v[52:55], v[100:115]
    ds_read_b128 v[28:31], v5 offset:0
    ds_read_b64_tr_b16 v[64:65], v10 offset:15360
    s_waitcnt lgkmcnt(6)
    v_mfma_f32_32x32x16_bf16 v[116:131], v[24:27], v[52:55], v[116:131]
    ds_read_b64_tr_b16 v[66:67], v10 offset:16640
    ds_read_b128 v[32:35], v9 offset:0
    s_waitcnt lgkmcnt(6)
    v_mfma_f32_32x32x16_bf16 v[132:147], v[20:23], v[56:59], v[132:147]
    ds_read_b64_tr_b16 v[68:69], v11 offset:15360
    ds_read_b64_tr_b16 v[70:71], v11 offset:16640
    v_mfma_f32_32x32x16_bf16 v[148:163], v[24:27], v[56:59], v[148:163]
    ds_read_b64_tr_b16 v[72:73], v12 offset:15360
    ds_read_b64_tr_b16 v[74:75], v12 offset:16640
    s_waitcnt lgkmcnt(8)
    v_mfma_f32_32x32x16_bf16 v[164:179], v[20:23], v[60:63], v[164:179]
    s_waitcnt lgkmcnt(0)
    s_barrier
    v_mfma_f32_32x32x16_bf16 v[100:115], v[28:31], v[64:67], v[100:115]
    ds_read_b128 v[20:23], v2 offset:16384
    ds_read_b64_tr_b16 v[52:53], v10 offset:20480
    v_mfma_f32_32x32x16_bf16 v[116:131], v[32:35], v[64:67], v[116:131]
    ds_read_b64_tr_b16 v[54:55], v10 offset:21760
    ds_read_b128 v[24:27], v6 offset:16384
    v_mfma_f32_32x32x16_bf16 v[132:147], v[28:31], v[68:71], v[132:147]
    ds_read_b64_tr_b16 v[56:57], v11 offset:20480
    ds_read_b64_tr_b16 v[58:59], v11 offset:21760
    v_mfma_f32_32x32x16_bf16 v[148:163], v[32:35], v[68:71], v[148:163]
    ds_read_b64_tr_b16 v[60:61], v12 offset:20480
    ds_read_b64_tr_b16 v[62:63], v12 offset:21760
    v_mfma_f32_32x32x16_bf16 v[164:179], v[28:31], v[72:75], v[164:179]
    s_waitcnt lgkmcnt(5)
    v_mfma_f32_32x32x16_bf16 v[100:115], v[20:23], v[52:55], v[100:115]
    ds_read_b128 v[28:31], v3 offset:16384
    ds_read_b64_tr_b16 v[64:65], v10 offset:25600
    s_waitcnt lgkmcnt(6)
    v_mfma_f32_32x32x16_bf16 v[116:131], v[24:27], v[52:55], v[116:131]
    ds_read_b64_tr_b16 v[66:67], v10 offset:26880
    ds_read_b128 v[32:35], v7 offset:16384
    s_waitcnt lgkmcnt(6)
    v_mfma_f32_32x32x16_bf16 v[132:147], v[20:23], v[56:59], v[132:147]
    ds_read_b64_tr_b16 v[68:69], v11 offset:25600
    ds_read_b64_tr_b16 v[70:71], v11 offset:26880
    v_mfma_f32_32x32x16_bf16 v[148:163], v[24:27], v[56:59], v[148:163]
    ds_read_b64_tr_b16 v[72:73], v12 offset:25600
    ds_read_b64_tr_b16 v[74:75], v12 offset:26880
    s_waitcnt lgkmcnt(8)
    v_mfma_f32_32x32x16_bf16 v[164:179], v[20:23], v[60:63], v[164:179]
    s_waitcnt lgkmcnt(5)
    v_mfma_f32_32x32x16_bf16 v[100:115], v[28:31], v[64:67], v[100:115]
    ds_read_b128 v[20:23], v4 offset:16384
    ds_read_b64_tr_b16 v[52:53], v10 offset:30720
    s_waitcnt lgkmcnt(6)
    v_mfma_f32_32x32x16_bf16 v[116:131], v[32:35], v[64:67], v[116:131]
    ds_read_b64_tr_b16 v[54:55], v10 offset:32000
    ds_read_b128 v[24:27], v8 offset:16384
    s_waitcnt lgkmcnt(6)
    v_mfma_f32_32x32x16_bf16 v[132:147], v[28:31], v[68:71], v[132:147]
    ds_read_b64_tr_b16 v[56:57], v11 offset:30720
    ds_read_b64_tr_b16 v[58:59], v11 offset:32000
    v_mfma_f32_32x32x16_bf16 v[148:163], v[32:35], v[68:71], v[148:163]
    ds_read_b64_tr_b16 v[60:61], v12 offset:30720
    ds_read_b64_tr_b16 v[62:63], v12 offset:32000
    s_waitcnt lgkmcnt(8)
    v_mfma_f32_32x32x16_bf16 v[164:179], v[28:31], v[72:75], v[164:179]
    s_waitcnt lgkmcnt(5)
    v_mfma_f32_32x32x16_bf16 v[100:115], v[20:23], v[52:55], v[100:115]
    ds_read_b128 v[28:31], v5 offset:16384
    ds_read_b64_tr_b16 v[64:65], v10 offset:35840
    s_waitcnt lgkmcnt(6)
    v_mfma_f32_32x32x16_bf16 v[116:131], v[24:27], v[52:55], v[116:131]
    ds_read_b64_tr_b16 v[66:67], v10 offset:37120
    ds_read_b128 v[32:35], v9 offset:16384
    s_waitcnt lgkmcnt(6)
    v_mfma_f32_32x32x16_bf16 v[132:147], v[20:23], v[56:59], v[132:147]
    ds_read_b64_tr_b16 v[68:69], v11 offset:35840
    ds_read_b64_tr_b16 v[70:71], v11 offset:37120
    v_mfma_f32_32x32x16_bf16 v[148:163], v[24:27], v[56:59], v[148:163]
    ds_read_b64_tr_b16 v[72:73], v12 offset:35840
    ds_read_b64_tr_b16 v[74:75], v12 offset:37120
    s_waitcnt lgkmcnt(8)
    v_mfma_f32_32x32x16_bf16 v[164:179], v[20:23], v[60:63], v[164:179]
    s_waitcnt lgkmcnt(0)
    s_barrier
    v_mfma_f32_32x32x16_bf16 v[100:115], v[28:31], v[64:67], v[100:115]
    ds_read_b128 v[20:23], v2 offset:32768
    ds_read_b64_tr_b16 v[52:53], v10 offset:40960
    v_mfma_f32_32x32x16_bf16 v[116:131], v[32:35], v[64:67], v[116:131]
    ds_read_b64_tr_b16 v[54:55], v10 offset:42240
    ds_read_b128 v[24:27], v6 offset:32768
    v_mfma_f32_32x32x16_bf16 v[132:147], v[28:31], v[68:71], v[132:147]
    ds_read_b64_tr_b16 v[56:57], v11 offset:40960
    ds_read_b64_tr_b16 v[58:59], v11 offset:42240
    v_mfma_f32_32x32x16_bf16 v[148:163], v[32:35], v[68:71], v[148:163]
    ds_read_b64_tr_b16 v[60:61], v12 offset:40960
    ds_read_b64_tr_b16 v[62:63], v12 offset:42240
    v_mfma_f32_32x32x16_bf16 v[164:179], v[28:31], v[72:75], v[164:179]
    s_waitcnt lgkmcnt(5)
    v_mfma_f32_32x32x16_bf16 v[100:115], v[20:23], v[52:55], v[100:115]
    ds_read_b128 v[28:31], v3 offset:32768
    ds_read_b64_tr_b16 v[64:65], v10 offset:46080
    s_waitcnt lgkmcnt(6)
    v_mfma_f32_32x32x16_bf16 v[116:131], v[24:27], v[52:55], v[116:131]
    ds_read_b64_tr_b16 v[66:67], v10 offset:47360
    ds_read_b128 v[32:35], v7 offset:32768
    s_waitcnt lgkmcnt(6)
    v_mfma_f32_32x32x16_bf16 v[132:147], v[20:23], v[56:59], v[132:147]
    ds_read_b64_tr_b16 v[68:69], v11 offset:46080
    ds_read_b64_tr_b16 v[70:71], v11 offset:47360
    v_mfma_f32_32x32x16_bf16 v[148:163], v[24:27], v[56:59], v[148:163]
    ds_read_b64_tr_b16 v[72:73], v12 offset:46080
    ds_read_b64_tr_b16 v[74:75], v12 offset:47360
    s_waitcnt lgkmcnt(8)
    v_mfma_f32_32x32x16_bf16 v[164:179], v[20:23], v[60:63], v[164:179]
    s_waitcnt lgkmcnt(5)
    v_mfma_f32_32x32x16_bf16 v[100:115], v[28:31], v[64:67], v[100:115]
    ds_read_b128 v[20:23], v4 offset:32768
    ds_read_b64_tr_b16 v[52:53], v10 offset:51200
    s_waitcnt lgkmcnt(6)
    v_mfma_f32_32x32x16_bf16 v[116:131], v[32:35], v[64:67], v[116:131]
    ds_read_b64_tr_b16 v[54:55], v10 offset:52480
    ds_read_b128 v[24:27], v8 offset:32768
    s_waitcnt lgkmcnt(6)
    v_mfma_f32_32x32x16_bf16 v[132:147], v[28:31], v[68:71], v[132:147]
    ds_read_b64_tr_b16 v[56:57], v11 offset:51200
    ds_read_b64_tr_b16 v[58:59], v11 offset:52480
    v_mfma_f32_32x32x16_bf16 v[148:163], v[32:35], v[68:71], v[148:163]
    ds_read_b64_tr_b16 v[60:61], v12 offset:51200
    ds_read_b64_tr_b16 v[62:63], v12 offset:52480
    s_waitcnt lgkmcnt(8)
    v_mfma_f32_32x32x16_bf16 v[164:179], v[28:31], v[72:75], v[164:179]
    s_waitcnt lgkmcnt(5)
    v_mfma_f32_32x32x16_bf16 v[100:115], v[20:23], v[52:55], v[100:115]
    ds_read_b128 v[28:31], v5 offset:32768
    ds_read_b64_tr_b16 v[64:65], v10 offset:56320
    s_waitcnt lgkmcnt(6)
    v_mfma_f32_32x32x16_bf16 v[116:131], v[24:27], v[52:55], v[116:131]
    ds_read_b64_tr_b16 v[66:67], v10 offset:57600
    ds_read_b128 v[32:35], v9 offset:32768
    s_waitcnt lgkmcnt(6)
    v_mfma_f32_32x32x16_bf16 v[132:147], v[20:23], v[56:59], v[132:147]
    ds_read_b64_tr_b16 v[68:69], v11 offset:56320
    ds_read_b64_tr_b16 v[70:71], v11 offset:57600
    v_mfma_f32_32x32x16_bf16 v[148:163], v[24:27], v[56:59], v[148:163]
    ds_read_b64_tr_b16 v[72:73], v12 offset:56320
    ds_read_b64_tr_b16 v[74:75], v12 offset:57600
    s_waitcnt lgkmcnt(8)
    v_mfma_f32_32x32x16_bf16 v[164:179], v[20:23], v[60:63], v[164:179]
    s_waitcnt lgkmcnt(0)
    s_barrier
    v_mfma_f32_32x32x16_bf16 v[100:115], v[28:31], v[64:67], v[100:115]
    ds_read_b128 v[20:23], v2 offset:0
    ds_read_b64_tr_b16 v[52:53], v10 offset:0
    v_mfma_f32_32x32x16_bf16 v[116:131], v[32:35], v[64:67], v[116:131]
    ds_read_b64_tr_b16 v[54:55], v10 offset:1280
    ds_read_b128 v[24:27], v6 offset:0
    v_mfma_f32_32x32x16_bf16 v[132:147], v[28:31], v[68:71], v[132:147]
    ds_read_b64_tr_b16 v[56:57], v11 offset:0
    ds_read_b64_tr_b16 v[58:59], v11 offset:1280
    v_mfma_f32_32x32x16_bf16 v[148:163], v[32:35], v[68:71], v[148:163]
    ds_read_b64_tr_b16 v[60:61], v12 offset:0
    ds_read_b64_tr_b16 v[62:63], v12 offset:1280
    v_mfma_f32_32x32x16_bf16 v[164:179], v[28:31], v[72:75], v[164:179]
    s_waitcnt lgkmcnt(5)
    v_mfma_f32_32x32x16_bf16 v[100:115], v[20:23], v[52:55], v[100:115]
    ds_read_b128 v[28:31], v3 offset:0
    ds_read_b64_tr_b16 v[64:65], v10 offset:5120
    s_waitcnt lgkmcnt(6)
    v_mfma_f32_32x32x16_bf16 v[116:131], v[24:27], v[52:55], v[116:131]
    ds_read_b64_tr_b16 v[66:67], v10 offset:6400
    ds_read_b128 v[32:35], v7 offset:0
    s_waitcnt lgkmcnt(6)
    v_mfma_f32_32x32x16_bf16 v[132:147], v[20:23], v[56:59], v[132:147]
    ds_read_b64_tr_b16 v[68:69], v11 offset:5120
    ds_read_b64_tr_b16 v[70:71], v11 offset:6400
    v_mfma_f32_32x32x16_bf16 v[148:163], v[24:27], v[56:59], v[148:163]
    ds_read_b64_tr_b16 v[72:73], v12 offset:5120
    ds_read_b64_tr_b16 v[74:75], v12 offset:6400
    s_waitcnt lgkmcnt(8)
    v_mfma_f32_32x32x16_bf16 v[164:179], v[20:23], v[60:63], v[164:179]
    s_waitcnt lgkmcnt(5)
    v_mfma_f32_32x32x16_bf16 v[100:115], v[28:31], v[64:67], v[100:115]
    ds_read_b128 v[20:23], v4 offset:0
    ds_read_b64_tr_b16 v[52:53], v10 offset:10240
    s_waitcnt lgkmcnt(6)
    v_mfma_f32_32x32x16_bf16 v[116:131], v[32:35], v[64:67], v[116:131]
    ds_read_b64_tr_b16 v[54:55], v10 offset:11520
    ds_read_b128 v[24:27], v8 offset:0
    s_waitcnt lgkmcnt(6)
    v_mfma_f32_32x32x16_bf16 v[132:147], v[28:31], v[68:71], v[132:147]
    ds_read_b64_tr_b16 v[56:57], v11 offset:10240
    ds_read_b64_tr_b16 v[58:59], v11 offset:11520
    v_mfma_f32_32x32x16_bf16 v[148:163], v[32:35], v[68:71], v[148:163]
    ds_read_b64_tr_b16 v[60:61], v12 offset:10240
    ds_read_b64_tr_b16 v[62:63], v12 offset:11520
    s_waitcnt lgkmcnt(8)
    v_mfma_f32_32x32x16_bf16 v[164:179], v[28:31], v[72:75], v[164:179]
    s_waitcnt lgkmcnt(5)
    v_mfma_f32_32x32x16_bf16 v[100:115], v[20:23], v[52:55], v[100:115]
    ds_read_b128 v[28:31], v5 offset:0
    ds_read_b64_tr_b16 v[64:65], v10 offset:15360
    s_waitcnt lgkmcnt(6)
    v_mfma_f32_32x32x16_bf16 v[116:131], v[24:27], v[52:55], v[116:131]
    ds_read_b64_tr_b16 v[66:67], v10 offset:16640
    ds_read_b128 v[32:35], v9 offset:0
    s_waitcnt lgkmcnt(6)
    v_mfma_f32_32x32x16_bf16 v[132:147], v[20:23], v[56:59], v[132:147]
    ds_read_b64_tr_b16 v[68:69], v11 offset:15360
    ds_read_b64_tr_b16 v[70:71], v11 offset:16640
    v_mfma_f32_32x32x16_bf16 v[148:163], v[24:27], v[56:59], v[148:163]
    ds_read_b64_tr_b16 v[72:73], v12 offset:15360
    ds_read_b64_tr_b16 v[74:75], v12 offset:16640
    s_waitcnt lgkmcnt(8)
    v_mfma_f32_32x32x16_bf16 v[164:179], v[20:23], v[60:63], v[164:179]
    s_waitcnt lgkmcnt(0)
    s_barrier
    v_mfma_f32_32x32x16_bf16 v[100:115], v[28:31], v[64:67], v[100:115]
    ds_read_b128 v[20:23], v2 offset:16384
    ds_read_b64_tr_b16 v[52:53], v10 offset:20480
    v_mfma_f32_32x32x16_bf16 v[116:131], v[32:35], v[64:67], v[116:131]
    ds_read_b64_tr_b16 v[54:55], v10 offset:21760
    ds_read_b128 v[24:27], v6 offset:16384
    v_mfma_f32_32x32x16_bf16 v[132:147], v[28:31], v[68:71], v[132:147]
    ds_read_b64_tr_b16 v[56:57], v11 offset:20480
    ds_read_b64_tr_b16 v[58:59], v11 offset:21760
    v_mfma_f32_32x32x16_bf16 v[148:163], v[32:35], v[68:71], v[148:163]
    ds_read_b64_tr_b16 v[60:61], v12 offset:20480
    ds_read_b64_tr_b16 v[62:63], v12 offset:21760
    v_mfma_f32_32x32x16_bf16 v[164:179], v[28:31], v[72:75], v[164:179]
    s_waitcnt lgkmcnt(5)
    v_mfma_f32_32x32x16_bf16 v[100:115], v[20:23], v[52:55], v[100:115]
    ds_read_b128 v[28:31], v3 offset:16384
    ds_read_b64_tr_b16 v[64:65], v10 offset:25600
    s_waitcnt lgkmcnt(6)
    v_mfma_f32_32x32x16_bf16 v[116:131], v[24:27], v[52:55], v[116:131]
    ds_read_b64_tr_b16 v[66:67], v10 offset:26880
    ds_read_b128 v[32:35], v7 offset:16384
    s_waitcnt lgkmcnt(6)
    v_mfma_f32_32x32x16_bf16 v[132:147], v[20:23], v[56:59], v[132:147]
    ds_read_b64_tr_b16 v[68:69], v11 offset:25600
    ds_read_b64_tr_b16 v[70:71], v11 offset:26880
    v_mfma_f32_32x32x16_bf16 v[148:163], v[24:27], v[56:59], v[148:163]
    ds_read_b64_tr_b16 v[72:73], v12 offset:25600
    ds_read_b64_tr_b16 v[74:75], v12 offset:26880
    s_waitcnt lgkmcnt(8)
    v_mfma_f32_32x32x16_bf16 v[164:179], v[20:23], v[60:63], v[164:179]
    s_waitcnt lgkmcnt(5)
    v_mfma_f32_32x32x16_bf16 v[100:115], v[28:31], v[64:67], v[100:115]
    ds_read_b128 v[20:23], v4 offset:16384
    ds_read_b64_tr_b16 v[52:53], v10 offset:30720
    s_waitcnt lgkmcnt(6)
    v_mfma_f32_32x32x16_bf16 v[116:131], v[32:35], v[64:67], v[116:131]
    ds_read_b64_tr_b16 v[54:55], v10 offset:32000
    ds_read_b128 v[24:27], v8 offset:16384
    s_waitcnt lgkmcnt(6)
    v_mfma_f32_32x32x16_bf16 v[132:147], v[28:31], v[68:71], v[132:147]
    ds_read_b64_tr_b16 v[56:57], v11 offset:30720
    ds_read_b64_tr_b16 v[58:59], v11 offset:32000
    v_mfma_f32_32x32x16_bf16 v[148:163], v[32:35], v[68:71], v[148:163]
    ds_read_b64_tr_b16 v[60:61], v12 offset:30720
    ds_read_b64_tr_b16 v[62:63], v12 offset:32000
    s_waitcnt lgkmcnt(8)
    v_mfma_f32_32x32x16_bf16 v[164:179], v[28:31], v[72:75], v[164:179]
    s_waitcnt lgkmcnt(5)
    v_mfma_f32_32x32x16_bf16 v[100:115], v[20:23], v[52:55], v[100:115]
    ds_read_b128 v[28:31], v5 offset:16384
    ds_read_b64_tr_b16 v[64:65], v10 offset:35840
    s_waitcnt lgkmcnt(6)
    v_mfma_f32_32x32x16_bf16 v[116:131], v[24:27], v[52:55], v[116:131]
    ds_read_b64_tr_b16 v[66:67], v10 offset:37120
    ds_read_b128 v[32:35], v9 offset:16384
    s_waitcnt lgkmcnt(6)
    v_mfma_f32_32x32x16_bf16 v[132:147], v[20:23], v[56:59], v[132:147]
    ds_read_b64_tr_b16 v[68:69], v11 offset:35840
    ds_read_b64_tr_b16 v[70:71], v11 offset:37120
    v_mfma_f32_32x32x16_bf16 v[148:163], v[24:27], v[56:59], v[148:163]
    ds_read_b64_tr_b16 v[72:73], v12 offset:35840
    ds_read_b64_tr_b16 v[74:75], v12 offset:37120
    s_waitcnt lgkmcnt(8)
    v_mfma_f32_32x32x16_bf16 v[164:179], v[20:23], v[60:63], v[164:179]
    s_waitcnt lgkmcnt(0)
    s_barrier
    v_mfma_f32_32x32x16_bf16 v[100:115], v[28:31], v[64:67], v[100:115]
    ds_read_b128 v[20:23], v2 offset:32768
    ds_read_b64_tr_b16 v[60:61], v12 offset:40960
    v_mfma_f32_32x32x16_bf16 v[116:131], v[32:35], v[64:67], v[116:131]
    ds_read_b64_tr_b16 v[62:63], v12 offset:42240
    ds_read_b128 v[36:39], v3 offset:32768
    v_mfma_f32_32x32x16_bf16 v[132:147], v[28:31], v[68:71], v[132:147]
    ds_read_b64_tr_b16 v[84:85], v12 offset:46080
    ds_read_b64_tr_b16 v[86:87], v12 offset:47360
    v_mfma_f32_32x32x16_bf16 v[148:163], v[32:35], v[68:71], v[148:163]
    ds_read_b128 v[44:47], v4 offset:32768
    ds_read_b64_tr_b16 v[96:97], v12 offset:51200
    v_mfma_f32_32x32x16_bf16 v[164:179], v[28:31], v[72:75], v[164:179]
    ds_read_b64_tr_b16 v[98:99], v12 offset:52480
    ds_read_b128 v[28:31], v5 offset:32768
    ds_read_b64_tr_b16 v[72:73], v12 offset:56320
    s_waitcnt lgkmcnt(8)
    v_mfma_f32_32x32x16_bf16 v[164:179], v[20:23], v[60:63], v[164:179]
    ds_read_b64_tr_b16 v[74:75], v12 offset:57600
    ds_read_b64_tr_b16 v[52:53], v10 offset:40960
    s_waitcnt lgkmcnt(7)
    v_mfma_f32_32x32x16_bf16 v[164:179], v[36:39], v[84:87], v[164:179]
    ds_read_b64_tr_b16 v[54:55], v10 offset:42240
    ds_read_b64_tr_b16 v[76:77], v10 offset:46080
    s_waitcnt lgkmcnt(6)
    v_mfma_f32_32x32x16_bf16 v[164:179], v[44:47], v[96:99], v[164:179]
    ds_read_b64_tr_b16 v[78:79], v10 offset:47360
    ds_read_b64_tr_b16 v[88:89], v10 offset:51200
    s_waitcnt lgkmcnt(5)
    v_mfma_f32_32x32x16_bf16 v[164:179], v[28:31], v[72:75], v[164:179]
    ds_read_b64_tr_b16 v[90:91], v10 offset:52480
    ds_read_b64_tr_b16 v[64:65], v10 offset:56320
    s_waitcnt lgkmcnt(5)
    v_mfma_f32_32x32x16_bf16 v[100:115], v[20:23], v[52:55], v[100:115]
    ds_read_b64_tr_b16 v[66:67], v10 offset:57600
    ds_read_b128 v[24:27], v6 offset:32768
    s_waitcnt lgkmcnt(5)
    v_mfma_f32_32x32x16_bf16 v[100:115], v[36:39], v[76:79], v[100:115]
    ds_read_b128 v[40:43], v7 offset:32768
    ds_read_b128 v[48:51], v8 offset:32768
    s_waitcnt lgkmcnt(5)
    v_mfma_f32_32x32x16_bf16 v[100:115], v[44:47], v[88:91], v[100:115]
    ds_read_b128 v[32:35], v9 offset:32768
    ds_read_b64_tr_b16 v[56:57], v11 offset:40960
    v_cvt_pk_bf16_f32 v164, v164, v165
    v_cvt_pk_bf16_f32 v165, v166, v167
    v_cvt_pk_bf16_f32 v166, v168, v169
    v_cvt_pk_bf16_f32 v167, v170, v171
    v_cndmask_b32 v164, v164, v16, s[76:77]
    v_cndmask_b32 v165, v165, v16, s[76:77]
    v_cndmask_b32 v166, v166, v16, s[76:77]
    s_waitcnt lgkmcnt(5)
    v_mfma_f32_32x32x16_bf16 v[100:115], v[28:31], v[64:67], v[100:115]
    ds_read_b64_tr_b16 v[58:59], v11 offset:42240
    ds_read_b64_tr_b16 v[80:81], v11 offset:46080
    v_cndmask_b32 v167, v167, v16, s[76:77]
    ds_write_b128 v182, v[164:167] offset:0
    v_cvt_pk_bf16_f32 v172, v172, v173
    v_cvt_pk_bf16_f32 v173, v174, v175
    v_cvt_pk_bf16_f32 v174, v176, v177
    v_cvt_pk_bf16_f32 v175, v178, v179
    v_cndmask_b32 v172, v172, v16, s[76:77]
    s_waitcnt lgkmcnt(7)
    v_mfma_f32_32x32x16_bf16 v[116:131], v[24:27], v[52:55], v[116:131]
    ds_read_b64_tr_b16 v[82:83], v11 offset:47360
    ds_read_b64_tr_b16 v[92:93], v11 offset:51200
    v_cndmask_b32 v173, v173, v16, s[76:77]
    v_cndmask_b32 v174, v174, v16, s[76:77]
    v_cndmask_b32 v175, v175, v16, s[76:77]
    ds_write_b128 v182, v[172:175] offset:96
    v_cvt_pk_bf16_f32 v100, v100, v101
    v_cvt_pk_bf16_f32 v101, v102, v103
    v_cvt_pk_bf16_f32 v102, v104, v105
    s_waitcnt lgkmcnt(9)
    v_mfma_f32_32x32x16_bf16 v[116:131], v[40:43], v[76:79], v[116:131]
    ds_read_b64_tr_b16 v[94:95], v11 offset:52480
    ds_read_b64_tr_b16 v[68:69], v11 offset:56320
    v_cvt_pk_bf16_f32 v103, v106, v107
    buffer_store_dwordx4 v[100:103], v180, s[16:19], s73 offen offset:0 sc1
    v_cvt_pk_bf16_f32 v108, v108, v109
    v_cvt_pk_bf16_f32 v109, v110, v111
    v_cvt_pk_bf16_f32 v110, v112, v113
    v_cvt_pk_bf16_f32 v111, v114, v115
    buffer_store_dwordx4 v[108:111], v180, s[16:19], s73 offen offset:512 sc1
    s_waitcnt lgkmcnt(10)
    v_mfma_f32_32x32x16_bf16 v[116:131], v[48:51], v[88:91], v[116:131]
    ds_read_b64_tr_b16 v[70:71], v11 offset:57600
    s_waitcnt lgkmcnt(10)
    v_mfma_f32_32x32x16_bf16 v[116:131], v[32:35], v[64:67], v[116:131]
    s_waitcnt lgkmcnt(8)
    v_mfma_f32_32x32x16_bf16 v[132:147], v[20:23], v[56:59], v[132:147]
    s_waitcnt lgkmcnt(5)
    v_mfma_f32_32x32x16_bf16 v[132:147], v[36:39], v[80:83], v[132:147]
    s_waitcnt lgkmcnt(2)
    v_mfma_f32_32x32x16_bf16 v[132:147], v[44:47], v[92:95], v[132:147]
    s_waitcnt lgkmcnt(0)
    v_mfma_f32_32x32x16_bf16 v[132:147], v[28:31], v[68:71], v[132:147]
    s_waitcnt lgkmcnt(0)
    s_barrier
    v_mfma_f32_32x32x16_bf16 v[148:163], v[24:27], v[56:59], v[148:163]
    v_mfma_f32_32x32x16_bf16 v[148:163], v[40:43], v[80:83], v[148:163]
    v_cvt_pk_bf16_f32 v116, v116, v117
    v_cvt_pk_bf16_f32 v117, v118, v119
    v_cvt_pk_bf16_f32 v118, v120, v121
    v_cvt_pk_bf16_f32 v119, v122, v123
    buffer_store_dwordx4 v[116:119], v180, s[16:19], s64 offen offset:0 sc1
    v_cvt_pk_bf16_f32 v124, v124, v125
    v_cvt_pk_bf16_f32 v125, v126, v127
    v_mfma_f32_32x32x16_bf16 v[148:163], v[48:51], v[92:95], v[148:163]
    v_cvt_pk_bf16_f32 v126, v128, v129
    v_cvt_pk_bf16_f32 v127, v130, v131
    buffer_store_dwordx4 v[124:127], v180, s[16:19], s64 offen offset:512 sc1
    v_cvt_pk_bf16_f32 v132, v132, v133
    v_cvt_pk_bf16_f32 v133, v134, v135
    v_cvt_pk_bf16_f32 v134, v136, v137
    v_cvt_pk_bf16_f32 v135, v138, v139
    v_mfma_f32_32x32x16_bf16 v[148:163], v[32:35], v[68:71], v[148:163]
    buffer_store_dwordx4 v[132:135], v181, s[16:19], s73 offen offset:0 sc1
    v_cvt_pk_bf16_f32 v140, v140, v141
    v_cvt_pk_bf16_f32 v141, v142, v143
    v_cvt_pk_bf16_f32 v142, v144, v145
    v_cvt_pk_bf16_f32 v143, v146, v147
    buffer_store_dwordx4 v[140:143], v181, s[16:19], s73 offen offset:512 sc1
    s_nop 5
    v_cvt_pk_bf16_f32 v148, v148, v149
    v_cvt_pk_bf16_f32 v149, v150, v151
    v_cvt_pk_bf16_f32 v150, v152, v153
    v_cvt_pk_bf16_f32 v151, v154, v155
    buffer_store_dwordx4 v[148:151], v181, s[16:19], s64 offen offset:0 sc1
    v_cvt_pk_bf16_f32 v156, v156, v157
    v_cvt_pk_bf16_f32 v157, v158, v159
    v_cvt_pk_bf16_f32 v158, v160, v161
    v_cvt_pk_bf16_f32 v159, v162, v163
    buffer_store_dwordx4 v[156:159], v181, s[16:19], s64 offen offset:512 sc1
    s_branch L_join
L_ssm_3:
    s_lshl_b32 s62, s60, 3
    s_add_u32 s62, s62, s61
    s_sub_u32 s62, s62, 24
    s_lshl_b32 s84, s62, 7
    s_add_u32 s84, s84, 14573568
    s_mov_b32 s92, 81920
    s_mul_i32 s93, s62, 3
    s_add_u32 s93, s93, 384
    s_mov_b32 s94, 6
    s_sub_u32 s91, s3, 5
    s_cmp_ge_u32 s3, 5
    s_cbranch_scc1 L_kg_6
    s_lshr_b32 s96, s3, 1
    s_and_b32 s97, s3, 1
    s_add_u32 s98, s96, s93
    s_lshl_b32 s99, s98, 7
    s_add_u32 s99, s99, s97
    s_lshl_b32 s99, s99, 1
    v_lshl_add_u32 v226, v1, 2, s99
    s_lshl_b32 s98, s98, 1
    v_mov_b32 v227, s98
    global_load_ushort v228, v226, s[32:33]
    global_load_ushort v229, v226, s[34:35]
    global_load_ushort v230, v227, s[44:45]
    s_mul_i32 s96, s96, 25328
    s_add_u32 s96, s96, s92
    s_cmp_eq_u32 s97, 0
    s_cselect_b32 s97, 16624, 0
    s_add_u32 s89, s96, s97
    s_mul_i32 s85, s60, 24
    s_add_u32 s85, s85, s61
    s_lshl_b32 s87, s60, 3
    s_add_u32 s87, s87, s61
    s_add_u32 s87, s87, 168
    s_cmp_lt_u32 s61, 24
    s_cselect_b32 s85, s85, s87
    s_lshl_b32 s85, s85, 7
    s_add_u32 s85, s85, 14581760
    s_and_b32 s86, s61, 7
    s_lshl_b32 s86, s86, 5
    s_lshl_b32 s87, s60, 2
    s_add_u32 s86, s86, s87
    s_lshr_b32 s87, s61, 3
    s_add_u32 s86, s86, s87
    s_lshl_b32 s86, s86, 7
    s_add_u32 s86, s86, 14614528
    s_waitcnt vmcnt(0)
    s_mov_b32 s100, 2
    s_branch L_kb_8
L_kbr_11:
    s_cmp_lg_u32 s3, 0
    s_cbranch_scc1 L_kb2_18
    s_mov_b32 s80, 5
    s_lshr_b32 s96, s80, 1
    s_and_b32 s97, s80, 1
    s_add_u32 s98, s96, s93
    s_lshl_b32 s99, s98, 7
    s_add_u32 s99, s99, s97
    s_lshl_b32 s99, s99, 1
    v_lshl_add_u32 v226, v1, 2, s99
    s_lshl_b32 s98, s98, 1
    v_mov_b32 v227, s98
    global_load_ushort v228, v226, s[32:33]
    global_load_ushort v229, v226, s[34:35]
    global_load_ushort v230, v227, s[44:45]
    s_mul_i32 s96, s96, 25328
    s_add_u32 s96, s96, s92
    s_cmp_eq_u32 s97, 0
    s_cselect_b32 s97, 16624, 0
    s_add_u32 s89, s96, s97
    s_waitcnt vmcnt(0)
    s_mov_b32 s100, 3
    s_branch L_kb_8
L_kbr_12:
L_kb2_18:
    s_barrier
    s_lshr_b32 s64, s62, 1
    s_lshl_b32 s64, s64, 6
    s_mul_i32 s64, s64, 1152
    s_and_b32 s65, s62, 1
    s_mul_i32 s65, s65, 576
    s_add_u32 s64, s64, s65
    s_lshl_b32 s65, s3, 10
    v_add_u32 v172, 0, v0
    v_mul_u32_u24 v173, 1821, v172
    v_lshrrev_b32 v173, 16, v173
    v_mul_u32_u24 v174, 576, v173
    s_add_u32 m0, s65, 0
    v_lshl_add_u32 v174, v172, 4, v174
    buffer_load_dwordx4 v174, s[24:27], s64 offen lds
    v_add_u32 v172, 320, v0
    v_mul_u32_u24 v173, 1821, v172
    v_lshrrev_b32 v173, 16, v173
    v_mul_u32_u24 v174, 576, v173
    s_add_u32 m0, s65, 5120
    v_lshl_add_u32 v174, v172, 4, v174
    buffer_load_dwordx4 v174, s[24:27], s64 offen lds
    v_add_u32 v172, 640, v0
    v_mul_u32_u24 v173, 1821, v172
    v_lshrrev_b32 v173, 16, v173
    v_mul_u32_u24 v174, 576, v173
    s_add_u32 m0, s65, 10240
    v_lshl_add_u32 v174, v172, 4, v174
    buffer_load_dwordx4 v174, s[24:27], s64 offen lds
    v_add_u32 v172, 960, v0
    v_mul_u32_u24 v173, 1821, v172
    v_lshrrev_b32 v173, 16, v173
    v_mul_u32_u24 v174, 576, v173
    s_add_u32 m0, s65, 15360
    v_lshl_add_u32 v174, v172, 4, v174
    buffer_load_dwordx4 v174, s[24:27], s64 offen lds
    v_add_u32 v172, 1280, v0
    v_mul_u32_u24 v173, 1821, v172
    v_lshrrev_b32 v173, 16, v173
    v_mul_u32_u24 v174, 576, v173
    s_add_u32 m0, s65, 20480
    v_lshl_add_u32 v174, v172, 4, v174
    buffer_load_dwordx4 v174, s[24:27], s64 offen lds
    v_add_u32 v172, 1600, v0
    v_mul_u32_u24 v173, 1821, v172
    v_lshrrev_b32 v173, 16, v173
    v_mul_u32_u24 v174, 576, v173
    s_add_u32 m0, s65, 25600
    v_lshl_add_u32 v174, v172, 4, v174
    buffer_load_dwordx4 v174, s[24:27], s64 offen lds
    v_add_u32 v172, 1920, v0
    v_mul_u32_u24 v173, 1821, v172
    v_lshrrev_b32 v173, 16, v173
    v_mul_u32_u24 v174, 576, v173
    s_add_u32 m0, s65, 30720
    v_lshl_add_u32 v174, v172, 4, v174
    buffer_load_dwordx4 v174, s[24:27], s64 offen lds
    s_cmp_ge_u32 s3, 1
    s_cbranch_scc1 L_utl_19
    v_add_u32 v172, 2240, v0
    v_mul_u32_u24 v173, 1821, v172
    v_lshrrev_b32 v173, 16, v173
    v_mul_u32_u24 v174, 576, v173
    s_add_u32 m0, s65, 35840
    v_lshl_add_u32 v174, v172, 4, v174
    buffer_load_dwordx4 v174, s[24:27], s64 offen lds
L_utl_19:
    v_lshrrev_b32 v175, 5, v1
    v_bfe_u32 v172, v1, 2, 2
    v_lshl_add_u32 v172, v175, 3, v172
    v_mul_u32_u24 v172, 576, v172
    v_bfe_u32 v174, v1, 4, 1
    v_lshl_add_u32 v172, v174, 5, v172
    v_and_b32 v174, 3, v1
    v_lshl_add_u32 v172, v174, 3, v172
    s_lshl_b32 s64, s3, 6
    v_add_u32 v172, s64, v172
    v_and_b32 v174, 7, v1
    v_xor_b32 v175, v175, v174
    v_and_b32 v173, 31, v1
    v_lshlrev_b32 v173, 7, v173
    v_lshl_add_u32 v173, v175, 4, v173
    s_lshl_b32 s64, s3, 13
    s_add_u32 s64, s64, 40960
    v_add_u32 v173, s64, v173
    v_lshrrev_b32 v175, 3, v1
    v_xor_b32 v174, v174, v175
    v_lshlrev_b32 v175, 12, v175
    v_lshl_add_u32 v175, v174, 4, v175
    v_lshl_add_u32 v174, v1, 4, s64
    s_lshr_b32 s64, s62, 1
    s_lshl_b32 s64, s64, 7
    s_and_b32 s65, s62, 1
    s_mul_i32 s65, s65, 9
    s_add_u32 s65, s65, s3
    s_lshl_b32 s65, s65, 17
    s_add_u32 s65, s65, s64
    s_add_u32 s65, s65, 9568256
    s_waitcnt vmcnt(0)
    s_barrier
    ds_read_b64_tr_b16 v[180:181], v172 offset:0
    ds_read_b64_tr_b16 v[182:183], v172 offset:2304
    ds_read_b64_tr_b16 v[184:185], v172 offset:9216
    ds_read_b64_tr_b16 v[186:187], v172 offset:11520
    ds_read_b64_tr_b16 v[188:189], v172 offset:18432
    ds_read_b64_tr_b16 v[190:191], v172 offset:20736
    ds_read_b64_tr_b16 v[192:193], v172 offset:27648
    ds_read_b64_tr_b16 v[194:195], v172 offset:29952
    ds_read_b64_tr_b16 v[196:197], v172 offset:320
    ds_read_b64_tr_b16 v[198:199], v172 offset:2624
    ds_read_b64_tr_b16 v[200:201], v172 offset:9536
    ds_read_b64_tr_b16 v[202:203], v172 offset:11840
    ds_read_b64_tr_b16 v[204:205], v172 offset:18752
    ds_read_b64_tr_b16 v[206:207], v172 offset:21056
    ds_read_b64_tr_b16 v[208:209], v172 offset:27968
    ds_read_b64_tr_b16 v[210:211], v172 offset:30272
    v_xor_b32 v176, 0, v173
    s_waitcnt lgkmcnt(0)
    ds_write_b128 v176, v[180:183] offset:0
    ds_write_b128 v176, v[196:199] offset:4096
    v_xor_b32 v176, 32, v173
    ds_write_b128 v176, v[184:187] offset:0
    ds_write_b128 v176, v[200:203] offset:4096
    v_xor_b32 v176, 64, v173
    ds_write_b128 v176, v[188:191] offset:0
    ds_write_b128 v176, v[204:207] offset:4096
    v_xor_b32 v176, 96, v173
    ds_write_b128 v176, v[192:195] offset:0
    ds_write_b128 v176, v[208:211] offset:4096
    ds_read_b128 v[180:183], v174 offset:0
    ds_read_b128 v[184:187], v174 offset:1024
    ds_read_b128 v[188:191], v174 offset:2048
    ds_read_b128 v[192:195], v174 offset:3072
    ds_read_b128 v[196:199], v174 offset:4096
    ds_read_b128 v[200:203], v174 offset:5120
    ds_read_b128 v[204:207], v174 offset:6144
    ds_read_b128 v[208:211], v174 offset:7168
    s_add_u32 s64, s65, 0
    s_waitcnt lgkmcnt(7)
    buffer_store_dwordx4 v[180:183], v175, s[16:19], s64 offen sc1
    s_add_u32 s64, s65, 32768
    s_waitcnt lgkmcnt(6)
    buffer_store_dwordx4 v[184:187], v175, s[16:19], s64 offen sc1
    s_add_u32 s64, s65, 65536
    s_waitcnt lgkmcnt(5)
    buffer_store_dwordx4 v[188:191], v175, s[16:19], s64 offen sc1
    s_add_u32 s64, s65, 98304
    s_waitcnt lgkmcnt(4)
    buffer_store_dwordx4 v[192:195], v175, s[16:19], s64 offen sc1
    s_cmp_eq_u32 s3, 4
    s_cbranch_scc1 L_utone_20
    s_add_u32 s64, s65, 655360
    s_waitcnt lgkmcnt(3)
    buffer_store_dwordx4 v[196:199], v175, s[16:19], s64 offen sc1
    s_add_u32 s64, s65, 688128
    s_waitcnt lgkmcnt(2)
    buffer_store_dwordx4 v[200:203], v175, s[16:19], s64 offen sc1
    s_add_u32 s64, s65, 720896
    s_waitcnt lgkmcnt(1)
    buffer_store_dwordx4 v[204:207], v175, s[16:19], s64 offen sc1
    s_add_u32 s64, s65, 753664
    s_waitcnt lgkmcnt(0)
    buffer_store_dwordx4 v[208:211], v175, s[16:19], s64 offen sc1
L_utone_20:
    v_mov_b32 v246, 0
    s_mov_b32 s87, 0
L_spin_21:
    global_load_dwordx2 v[250:251], v246, s[48:49] sc1
    s_waitcnt vmcnt(0)
    v_cmp_eq_u32 vcc, 0, v250
    s_add_u32 s87, s87, 1
    s_cbranch_vccz L_spun_22
    s_sleep 2
    s_cmp_lt_u32 s87, 65536
    s_cbranch_scc1 L_spin_21
L_spun_22:
    s_barrier
    s_cmp_lg_u32 s3, 0
    s_cbranch_scc1 L_fset_23
    v_mov_b32 v242, 0
    s_mov_b64 exec, 1
    buffer_store_dwordx2 v[250:251], v242, s[16:19], s84 offen sc1
    s_mov_b64 exec, -1
L_fset_23:
    s_barrier
    s_barrier
    s_barrier
    s_barrier
    s_barrier
    s_barrier
    s_barrier
    s_branch L_join
L_kb_8:
    v_lshlrev_b32 v230, 16, v230
    s_mov_b32 s68, 0x3fb8aa3b
    v_mul_f32 v226, s68, v230
    v_fma_f32 v227, v230, s68, -v226
    v_exp_f32 v226, v226
    v_fmac_f32 v227, 0x32a57060, v230
    v_mul_f32 v227, 0x3f317218, v227
    v_fmac_f32 v226, v226, v227
    v_cvt_pk_bf16_f32 v226, v226, v226
    v_and_b32 v231, 0xffff0000, v226
    s_mov_b32 m0, s89
    v_lshlrev_b32 v228, 16, v228
    v_lshlrev_b32 v229, 16, v229
    v_mul_f32 v228, v231, v228
    v_mul_f32 v229, v231, v229
    v_mul_f32 v228, s68, v228
    v_mul_f32 v229, 0.15915494, v229
    v_mul_f32 v226, 0x41000000, v228
    v_mul_f32 v227, 0x41000000, v229
    v_exp_f32 v226, v226
    v_fract_f32 v227, v227
    v_cos_f32 v214, v227
    v_sin_f32 v215, v227
    v_mul_f32 v214, v226, v214
    v_mul_f32 v215, v226, v215
    v_mov_b32 v226, 0x00003f80
    ds_write_addtid_b32 v226
    v_pk_mul_f32 v[216:217], v[214:215], v[214:215] op_sel:[0,0] op_sel_hi:[1,0]
    v_pk_fma_f32 v[216:217], v[214:215], v[214:215], v[216:217] op_sel:[1,1,0] op_sel_hi:[0,1,1] neg_lo:[1,0,0]
    v_cvt_pk_bf16_f32 v232, v216, v217
    v_cvt_pk_bf16_f32 v233, v214, v215
    v_pk_mul_f32 v[224:225], v[214:215], v[216:217] op_sel:[0,0] op_sel_hi:[1,0]
    v_pk_mul_f32 v[220:221], v[216:217], v[216:217] op_sel:[0,0] op_sel_hi:[1,0]
    ds_write_addtid_b32 v232 offset:544
    ds_write_addtid_b32 v233 offset:272
    v_pk_fma_f32 v[224:225], v[214:215], v[216:217], v[224:225] op_sel:[1,1,0] op_sel_hi:[0,1,1] neg_lo:[1,0,0]
    v_pk_fma_f32 v[220:221], v[216:217], v[216:217], v[220:221] op_sel:[1,1,0] op_sel_hi:[0,1,1] neg_lo:[1,0,0]
    v_cvt_pk_bf16_f32 v234, v224, v225
    v_cvt_pk_bf16_f32 v235, v220, v221
    v_pk_mul_f32 v[222:223], v[224:225], v[216:217] op_sel:[0,0] op_sel_hi:[1,0]
    v_pk_mul_f32 v[218:219], v[220:221], v[216:217] op_sel:[0,0] op_sel_hi:[1,0]
    ds_write_addtid_b32 v234 offset:816
    ds_write_addtid_b32 v235 offset:1088
    v_pk_fma_f32 v[222:223], v[224:225], v[216:217], v[222:223] op_sel:[1,1,0] op_sel_hi:[0,1,1] neg_lo:[1,0,0]
    v_pk_fma_f32 v[218:219], v[220:221], v[216:217], v[218:219] op_sel:[1,1,0] op_sel_hi:[0,1,1] neg_lo:[1,0,0]
    v_cvt_pk_bf16_f32 v232, v222, v223
    v_cvt_pk_bf16_f32 v233, v218, v219
    v_pk_mul_f32 v[224:225], v[222:223], v[216:217] op_sel:[0,0] op_sel_hi:[1,0]
    v_pk_mul_f32 v[220:221], v[218:219], v[216:217] op_sel:[0,0] op_sel_hi:[1,0]
    ds_write_addtid_b32 v232 offset:1360
    ds_write_addtid_b32 v233 offset:1632
    v_pk_fma_f32 v[224:225], v[222:223], v[216:217], v[224:225] op_sel:[1,1,0] op_sel_hi:[0,1,1] neg_lo:[1,0,0]
    v_pk_fma_f32 v[220:221], v[218:219], v[216:217], v[220:221] op_sel:[1,1,0] op_sel_hi:[0,1,1] neg_lo:[1,0,0]
    v_cvt_pk_bf16_f32 v234, v224, v225
    v_cvt_pk_bf16_f32 v235, v220, v221
    v_pk_mul_f32 v[222:223], v[224:225], v[216:217] op_sel:[0,0] op_sel_hi:[1,0]
    v_pk_mul_f32 v[218:219], v[220:221], v[216:217] op_sel:[0,0] op_sel_hi:[1,0]
    ds_write_addtid_b32 v234 offset:1904
    ds_write_addtid_b32 v235 offset:2176
    v_pk_fma_f32 v[222:223], v[224:225], v[216:217], v[222:223] op_sel:[1,1,0] op_sel_hi:[0,1,1] neg_lo:[1,0,0]
    v_pk_fma_f32 v[218:219], v[220:221], v[216:217], v[218:219] op_sel:[1,1,0] op_sel_hi:[0,1,1] neg_lo:[1,0,0]
    v_cvt_pk_bf16_f32 v232, v222, v223
    v_cvt_pk_bf16_f32 v233, v218, v219
    v_pk_mul_f32 v[224:225], v[222:223], v[216:217] op_sel:[0,0] op_sel_hi:[1,0]
    v_pk_mul_f32 v[220:221], v[218:219], v[216:217] op_sel:[0,0] op_sel_hi:[1,0]
    ds_write_addtid_b32 v232 offset:2448
    ds_write_addtid_b32 v233 offset:2720
    v_pk_fma_f32 v[224:225], v[222:223], v[216:217], v[224:225] op_sel:[1,1,0] op_sel_hi:[0,1,1] neg_lo:[1,0,0]
    v_pk_fma_f32 v[220:221], v[218:219], v[216:217], v[220:221] op_sel:[1,1,0] op_sel_hi:[0,1,1] neg_lo:[1,0,0]
    v_cvt_pk_bf16_f32 v234, v224, v225
    v_cvt_pk_bf16_f32 v235, v220, v221
    v_pk_mul_f32 v[222:223], v[224:225], v[216:217] op_sel:[0,0] op_sel_hi:[1,0]
    v_pk_mul_f32 v[218:219], v[220:221], v[216:217] op_sel:[0,0] op_sel_hi:[1,0]
    ds_write_addtid_b32 v234 offset:2992
    ds_write_addtid_b32 v235 offset:3264
    v_pk_fma_f32 v[222:223], v[224:225], v[216:217], v[222:223] op_sel:[1,1,0] op_sel_hi:[0,1,1] neg_lo:[1,0,0]
    v_pk_fma_f32 v[218:219], v[220:221], v[216:217], v[218:219] op_sel:[1,1,0] op_sel_hi:[0,1,1] neg_lo:[1,0,0]
    v_cvt_pk_bf16_f32 v232, v222, v223
    v_cvt_pk_bf16_f32 v233, v218, v219
    v_pk_mul_f32 v[224:225], v[222:223], v[216:217] op_sel:[0,0] op_sel_hi:[1,0]
    v_pk_mul_f32 v[220:221], v[218:219], v[216:217] op_sel:[0,0] op_sel_hi:[1,0]
    ds_write_addtid_b32 v232 offset:3536
    ds_write_addtid_b32 v233 offset:3808
    v_pk_fma_f32 v[224:225], v[222:223], v[216:217], v[224:225] op_sel:[1,1,0] op_sel_hi:[0,1,1] neg_lo:[1,0,0]
    v_pk_fma_f32 v[220:221], v[218:219], v[216:217], v[220:221] op_sel:[1,1,0] op_sel_hi:[0,1,1] neg_lo:[1,0,0]
    v_cvt_pk_bf16_f32 v234, v224, v225
    v_cvt_pk_bf16_f32 v235, v220, v221
    v_pk_mul_f32 v[222:223], v[224:225], v[216:217] op_sel:[0,0] op_sel_hi:[1,0]
    v_pk_mul_f32 v[218:219], v[220:221], v[216:217] op_sel:[0,0] op_sel_hi:[1,0]
    ds_write_addtid_b32 v234 offset:4080
    ds_write_addtid_b32 v235 offset:4352
    v_pk_fma_f32 v[222:223], v[224:225], v[216:217], v[222:223] op_sel:[1,1,0] op_sel_hi:[0,1,1] neg_lo:[1,0,0]
    v_pk_fma_f32 v[218:219], v[220:221], v[216:217], v[218:219] op_sel:[1,1,0] op_sel_hi:[0,1,1] neg_lo:[1,0,0]
    v_cvt_pk_bf16_f32 v232, v222, v223
    v_cvt_pk_bf16_f32 v233, v218, v219
    v_pk_mul_f32 v[224:225], v[222:223], v[216:217] op_sel:[0,0] op_sel_hi:[1,0]
    v_pk_mul_f32 v[220:221], v[218:219], v[216:217] op_sel:[0,0] op_sel_hi:[1,0]
    ds_write_addtid_b32 v232 offset:4624
    ds_write_addtid_b32 v233 offset:4896
    v_pk_fma_f32 v[224:225], v[222:223], v[216:217], v[224:225] op_sel:[1,1,0] op_sel_hi:[0,1,1] neg_lo:[1,0,0]
    v_pk_fma_f32 v[220:221], v[218:219], v[216:217], v[220:221] op_sel:[1,1,0] op_sel_hi:[0,1,1] neg_lo:[1,0,0]
    v_cvt_pk_bf16_f32 v234, v224, v225
    v_cvt_pk_bf16_f32 v235, v220, v221
    v_pk_mul_f32 v[222:223], v[224:225], v[216:217] op_sel:[0,0] op_sel_hi:[1,0]
    v_pk_mul_f32 v[218:219], v[220:221], v[216:217] op_sel:[0,0] op_sel_hi:[1,0]
    ds_write_addtid_b32 v234 offset:5168
    ds_write_addtid_b32 v235 offset:5440
    v_pk_fma_f32 v[222:223], v[224:225], v[216:217], v[222:223] op_sel:[1,1,0] op_sel_hi:[0,1,1] neg_lo:[1,0,0]
    v_pk_fma_f32 v[218:219], v[220:221], v[216:217], v[218:219] op_sel:[1,1,0] op_sel_hi:[0,1,1] neg_lo:[1,0,0]
    v_cvt_pk_bf16_f32 v232, v222, v223
    v_cvt_pk_bf16_f32 v233, v218, v219
    v_pk_mul_f32 v[224:225], v[222:223], v[216:217] op_sel:[0,0] op_sel_hi:[1,0]
    v_pk_mul_f32 v[220:221], v[218:219], v[216:217] op_sel:[0,0] op_sel_hi:[1,0]
    ds_write_addtid_b32 v232 offset:5712
    ds_write_addtid_b32 v233 offset:5984
    v_pk_fma_f32 v[224:225], v[222:223], v[216:217], v[224:225] op_sel:[1,1,0] op_sel_hi:[0,1,1] neg_lo:[1,0,0]
    v_pk_fma_f32 v[220:221], v[218:219], v[216:217], v[220:221] op_sel:[1,1,0] op_sel_hi:[0,1,1] neg_lo:[1,0,0]
    v_cvt_pk_bf16_f32 v234, v224, v225
    v_cvt_pk_bf16_f32 v235, v220, v221
    v_pk_mul_f32 v[222:223], v[224:225], v[216:217] op_sel:[0,0] op_sel_hi:[1,0]
    v_pk_mul_f32 v[218:219], v[220:221], v[216:217] op_sel:[0,0] op_sel_hi:[1,0]
    ds_write_addtid_b32 v234 offset:6256
    ds_write_addtid_b32 v235 offset:6528
    v_pk_fma_f32 v[222:223], v[224:225], v[216:217], v[222:223] op_sel:[1,1,0] op_sel_hi:[0,1,1] neg_lo:[1,0,0]
    v_pk_fma_f32 v[218:219], v[220:221], v[216:217], v[218:219] op_sel:[1,1,0] op_sel_hi:[0,1,1] neg_lo:[1,0,0]
    v_cvt_pk_bf16_f32 v232, v222, v223
    v_cvt_pk_bf16_f32 v233, v218, v219
    v_pk_mul_f32 v[224:225], v[222:223], v[216:217] op_sel:[0,0] op_sel_hi:[1,0]
    v_pk_mul_f32 v[220:221], v[218:219], v[216:217] op_sel:[0,0] op_sel_hi:[1,0]
    ds_write_addtid_b32 v232 offset:6800
    ds_write_addtid_b32 v233 offset:7072
    v_pk_fma_f32 v[224:225], v[222:223], v[216:217], v[224:225] op_sel:[1,1,0] op_sel_hi:[0,1,1] neg_lo:[1,0,0]
    v_pk_fma_f32 v[220:221], v[218:219], v[216:217], v[220:221] op_sel:[1,1,0] op_sel_hi:[0,1,1] neg_lo:[1,0,0]
    v_cvt_pk_bf16_f32 v234, v224, v225
    v_cvt_pk_bf16_f32 v235, v220, v221
    v_pk_mul_f32 v[222:223], v[224:225], v[216:217] op_sel:[0,0] op_sel_hi:[1,0]
    v_pk_mul_f32 v[218:219], v[220:221], v[216:217] op_sel:[0,0] op_sel_hi:[1,0]
    ds_write_addtid_b32 v234 offset:7344
    ds_write_addtid_b32 v235 offset:7616
    v_pk_fma_f32 v[222:223], v[224:225], v[216:217], v[222:223] op_sel:[1,1,0] op_sel_hi:[0,1,1] neg_lo:[1,0,0]
    v_pk_fma_f32 v[218:219], v[220:221], v[216:217], v[218:219] op_sel:[1,1,0] op_sel_hi:[0,1,1] neg_lo:[1,0,0]
    v_cvt_pk_bf16_f32 v232, v222, v223
    v_cvt_pk_bf16_f32 v233, v218, v219
    v_pk_mul_f32 v[224:225], v[222:223], v[216:217] op_sel:[0,0] op_sel_hi:[1,0]
    ds_write_addtid_b32 v232 offset:7888
    ds_write_addtid_b32 v233 offset:8160
    v_pk_fma_f32 v[224:225], v[222:223], v[216:217], v[224:225] op_sel:[1,1,0] op_sel_hi:[0,1,1] neg_lo:[1,0,0]
    v_cvt_pk_bf16_f32 v234, v224, v225
    ds_write_addtid_b32 v234 offset:8432
    s_waitcnt lgkmcnt(0)
    s_cmp_eq_u32 s100, 0
    s_cbranch_scc1 L_kbr_9
    s_cmp_eq_u32 s100, 1
    s_cbranch_scc1 L_kbr_10
    s_cmp_eq_u32 s100, 2
    s_cbranch_scc1 L_kbr_11
    s_branch L_kbr_12
L_kg_6:
    s_mul_i32 s66, s91, 25328
    s_add_u32 s66, s66, s92
    s_add_u32 s66, s66, 9280
    s_mov_b32 s95, s91
    s_add_u32 s91, s91, s93
    v_lshlrev_b32 v16, 2, v1
    v_mov_b32 v242, 0
    s_lshl_b32 s87, s2, 3
    s_add_u32 s87, s87, s3
    s_cmp_lg_u32 s87, 7
    s_cbranch_scc1 L_tld_24
    s_mov_b32 s87, 14745600
    buffer_load_dwordx2 v[244:245], v242, s[16:19], s87 offen sc1
L_tld_24:
    s_lshl_b32 s67, s91, 8
    v_add_u32 v2, s67, v16
    s_lshl_b32 s67, s91, 1
    v_mov_b32 v3, s67
    global_load_dword v18, v2, s[32:33]
    global_load_dword v19, v2, s[34:35]
    global_load_dword v20, v2, s[36:37]
    global_load_dword v21, v2, s[38:39]
    global_load_dword v22, v2, s[40:41]
    global_load_dword v23, v2, s[42:43]
    global_load_ushort v24, v3, s[44:45]
    global_load_ushort v25, v3, s[46:47]
    s_mov_b32 s70, 0x03020100
    s_mov_b32 s71, 0x0a090808
    s_mov_b32 s72, 0x07060504
    s_mov_b32 s73, 0x0c0b0a0a
    s_mov_b32 s74, 0x15141313
    s_mov_b32 s75, 0x100f0e0d
    s_mov_b32 s76, 0x18171615
    s_mov_b32 s77, 0x1a191211
    v_bfe_u32 v2, v1, 2, 3
    v_mov_b32 v3, s70
    v_cmp_eq_u32 s[78:79], 1, v2
    v_mov_b32 v4, s71
    s_nop 0
    v_cndmask_b32 v3, v3, v4, s[78:79]
    v_cmp_eq_u32 s[78:79], 2, v2
    v_mov_b32 v4, s72
    s_nop 0
    v_cndmask_b32 v3, v3, v4, s[78:79]
    v_cmp_eq_u32 s[78:79], 3, v2
    v_mov_b32 v4, s73
    s_nop 0
    v_cndmask_b32 v3, v3, v4, s[78:79]
    v_cmp_eq_u32 s[78:79], 4, v2
    v_mov_b32 v4, s74
    s_nop 0
    v_cndmask_b32 v3, v3, v4, s[78:79]
    v_cmp_eq_u32 s[78:79], 5, v2
    v_mov_b32 v4, s75
    s_nop 0
    v_cndmask_b32 v3, v3, v4, s[78:79]
    v_cmp_eq_u32 s[78:79], 6, v2
    v_mov_b32 v4, s76
    s_nop 0
    v_cndmask_b32 v3, v3, v4, s[78:79]
    v_cmp_eq_u32 s[78:79], 7, v2
    v_mov_b32 v4, s77
    s_nop 0
    v_cndmask_b32 v3, v3, v4, s[78:79]
    v_and_b32 v2, 3, v1
    v_lshlrev_b32 v2, 3, v2
    v_bfe_u32 v3, v3, v2, 8
    v_mul_u32_u24 v3, 272, v3
    v_lshrrev_b32 v4, 5, v1
    v_lshl_add_u32 v2, v4, 4, s66
    v_add_u32 v8, v2, v3
    v_and_b32 v3, 31, v1
    v_mul_u32_u24 v5, 272, v3
    v_add_u32 v9, v2, v5
    v_add_u32 v9, 7344, v9
    v_cmp_gt_u32 s[70:71], 32, v1
    v_and_b32 v5, 1, v1
    v_cmp_eq_u32 s[72:73], 1, v5
    v_mov_b32 v5, 0x01000504
    v_mov_b32 v6, 0x05040504
    v_cndmask_b32 v12, v5, v6, s[72:73]
    v_mov_b32 v5, 0x03020302
    v_cndmask_b32 v10, v5, v12, s[70:71]
    v_mov_b32 v5, 0x01000302
    v_mov_b32 v6, 0x01000100
    v_cndmask_b32 v11, v5, v6, s[70:71]
    v_lshlrev_b32 v3, 4, v3
    v_lshlrev_b32 v4, 9, v4
    v_sub_u32 v3, 4080, v3
    v_sub_u32 v13, v3, v4
    v_lshlrev_b32 v4, 1, v4
    v_subrev_u32 v3, 2560, v3
    v_add_u32 v14, v3, v4
    v_cmp_eq_u32 s[74:75], 0, v1
    s_add_u32 s67, s66, 16
    v_add_u32 v13, s67, v13
    v_add_u32 v14, s67, v14
    v_subrev_u32 v15, 3072, v13
    v_lshrrev_b32 v4, 5, v1
    v_mul_u32_u24 v4, 4096, v4
    v_add3_u32 v17, v4, v16, s67
    s_waitcnt vmcnt(0)
    s_lshl_b32 s87, s2, 3
    s_add_u32 s87, s87, s3
    s_cmp_lg_u32 s87, 7
    s_cbranch_scc1 L_tpub_25
    v_add_u32 v244, 1, v244
    v_max_u32 v244, 1, v244
    s_mov_b32 s87, 14745600
    s_mov_b64 exec, 1
    global_store_dwordx2 v242, v[244:245], s[48:49] sc1
    buffer_store_dwordx2 v[244:245], v242, s[16:19], s87 offen sc1
    s_mov_b64 exec, -1
L_tpub_25:
    s_lshl_b32 s79, s95, 2
    s_add_u32 s79, s79, 163744
    v_mov_b32 v195, s79
    v_mov_b32 v246, 0
    ds_write_b32 v195, v246
    v_mov_b32 v255, 1
    v_lshlrev_b32 v24, 16, v24
    s_mov_b32 s68, 0x3fb8aa3b
    v_mul_f32 v2, s68, v24
    v_fma_f32 v3, v24, s68, -v2
    v_exp_f32 v2, v2
    v_fmac_f32 v3, 0x32a57060, v24
    v_mul_f32 v3, 0x3f317218, v3
    v_fmac_f32 v2, v2, v3
    v_cvt_pk_bf16_f32 v2, v2, v2
    v_and_b32 v26, 0xffff0000, v2
    v_lshlrev_b32 v25, 16, v25
    s_mov_b32 m0, s66
    s_mov_b32 s69, 0
L_kpass_26:
    v_lshlrev_b32 v36, 16, v18
    v_lshlrev_b32 v37, 16, v19
    v_lshlrev_b32 v38, 16, v20
    v_lshlrev_b32 v39, 16, v21
    v_lshlrev_b32 v40, 16, v22
    v_lshlrev_b32 v41, 16, v23
    v_mul_f32 v36, v26, v36
    v_mul_f32 v37, v26, v37
    v_mul_f32 v38, v26, v38
    v_mul_f32 v39, v26, v39
    v_mul_f32 v36, s68, v36
    v_mul_f32 v37, 0.15915494, v37
    v_mul_f32 v46, v38, v40
    v_mul_f32 v47, v39, v40
    v_fma_f32 v46, -v39, v41, v46
    v_fmac_f32 v47, v38, v41
    v_exp_f32 v2, v36
    v_fract_f32 v3, v37
    v_cos_f32 v28, v3
    v_sin_f32 v29, v3
    v_mul_f32 v28, v2, v28
    v_mul_f32 v29, v2, v29
    v_mul_f32 v2, 0x43800000, v36
    v_mul_f32 v3, 0x43800000, v37
    v_exp_f32 v2, v2
    v_fract_f32 v3, v3
    v_cos_f32 v34, v3
    v_sin_f32 v35, v3
    v_mul_f32 v34, v2, v34
    v_mul_f32 v35, v2, v35
    v_mul_f32 v48, v46, v28
    v_mul_f32 v49, v47, v28
    v_fma_f32 v48, -v47, v29, v48
    v_fmac_f32 v49, v46, v29
    v_cvt_pk_bf16_f32 v72, v46, -v47
    v_cvt_pk_bf16_f32 v73, v48, -v49
    v_mul_f32 v50, v48, v28
    v_mul_f32 v51, v49, v28
    ds_write_addtid_b32 v72 offset:0
    ds_write_addtid_b32 v73 offset:272
    v_fma_f32 v50, -v49, v29, v50
    v_fmac_f32 v51, v48, v29
    v_cvt_pk_bf16_f32 v74, v50, -v51
    v_mul_f32 v52, v50, v28
    v_mul_f32 v53, v51, v28
    ds_write_addtid_b32 v74 offset:544
    v_fma_f32 v52, -v51, v29, v52
    v_fmac_f32 v53, v50, v29
    v_cvt_pk_bf16_f32 v75, v52, -v53
    v_mul_f32 v54, v52, v28
    v_mul_f32 v55, v53, v28
    ds_write_addtid_b32 v75 offset:816
    v_fma_f32 v54, -v53, v29, v54
    v_fmac_f32 v55, v52, v29
    v_cvt_pk_bf16_f32 v72, v54, -v55
    v_mul_f32 v56, v54, v28
    v_mul_f32 v57, v55, v28
    ds_write_addtid_b32 v72 offset:1088
    v_fma_f32 v56, -v55, v29, v56
    v_fmac_f32 v57, v54, v29
    v_cvt_pk_bf16_f32 v73, v56, -v57
    v_mul_f32 v58, v56, v28
    v_mul_f32 v59, v57, v28
    ds_write_addtid_b32 v73 offset:1360
    v_fma_f32 v58, -v57, v29, v58
    v_fmac_f32 v59, v56, v29
    v_cvt_pk_bf16_f32 v74, v58, -v59
    v_mul_f32 v60, v58, v28
    v_mul_f32 v61, v59, v28
    ds_write_addtid_b32 v74 offset:1632
    v_fma_f32 v60, -v59, v29, v60
    v_fmac_f32 v61, v58, v29
    v_cvt_pk_bf16_f32 v75, v60, -v61
    v_mul_f32 v62, v60, v28
    v_mul_f32 v63, v61, v28
    ds_write_addtid_b32 v75 offset:1904
    v_fma_f32 v62, -v61, v29, v62
    v_fmac_f32 v63, v60, v29
    v_mul_f32 v48, v46, v34
    v_mul_f32 v49, v47, v34
    v_fma_f32 v48, -v47, v35, v48
    v_fmac_f32 v49, v46, v35
    v_cvt_pk_bf16_f32 v72, v48, -v49
    v_mul_f32 v52, v50, v34
    v_mul_f32 v53, v51, v34
    v_mul_f32 v56, v54, v34
    v_mul_f32 v57, v55, v34
    ds_write_addtid_b32 v72 offset:2176
    v_fma_f32 v52, -v51, v35, v52
    v_fmac_f32 v53, v50, v35
    v_fma_f32 v56, -v55, v35, v56
    v_fmac_f32 v57, v54, v35
    v_cvt_pk_bf16_f32 v73, v52, -v53
    v_cvt_pk_bf16_f32 v74, v56, -v57
    v_mul_f32 v60, v58, v34
    v_mul_f32 v61, v59, v34
    v_mul_f32 v38, v62, v34
    v_mul_f32 v39, v63, v34
    ds_write_addtid_b32 v73 offset:2448
    ds_write_addtid_b32 v74 offset:2720
    v_fma_f32 v60, -v59, v35, v60
    v_fmac_f32 v61, v58, v35
    v_fma_f32 v38, -v63, v35, v38
    v_fmac_f32 v39, v62, v35
    v_cvt_pk_bf16_f32 v75, v60, -v61
    v_cvt_pk_bf16_f32 v72, v38, -v39
    v_mul_f32 v40, v48, v34
    v_mul_f32 v41, v49, v34
    v_mul_f32 v46, v56, v34
    v_mul_f32 v47, v57, v34
    ds_write_addtid_b32 v75 offset:2992
    ds_write_addtid_b32 v72 offset:3264
    v_fma_f32 v40, -v49, v35, v40
    v_fmac_f32 v41, v48, v35
    v_fma_f32 v46, -v57, v35, v46
    v_fmac_f32 v47, v56, v35
    v_cvt_pk_bf16_f32 v73, v40, -v41
    v_cvt_pk_bf16_f32 v74, v46, -v47
    v_mul_f32 v50, v38, v34
    v_mul_f32 v51, v39, v34
    v_mul_f32 v54, v40, v34
    v_mul_f32 v55, v41, v34
    ds_write_addtid_b32 v73 offset:3536
    ds_write_addtid_b32 v74 offset:3808
    v_fma_f32 v50, -v39, v35, v50
    v_fmac_f32 v51, v38, v35
    v_fma_f32 v54, -v41, v35, v54
    v_fmac_f32 v55, v40, v35
    v_cvt_pk_bf16_f32 v75, v50, -v51
    v_cvt_pk_bf16_f32 v72, v54, -v55
    v_mul_f32 v58, v46, v34
    v_mul_f32 v59, v47, v34
    v_mul_f32 v62, v50, v34
    v_mul_f32 v63, v51, v34
    ds_write_addtid_b32 v75 offset:4080
    ds_write_addtid_b32 v72 offset:4352
    v_fma_f32 v58, -v47, v35, v58
    v_fmac_f32 v59, v46, v35
    v_fma_f32 v62, -v51, v35, v62
    v_fmac_f32 v63, v50, v35
    v_cvt_pk_bf16_f32 v73, v58, -v59
    v_cvt_pk_bf16_f32 v74, v62, -v63
    v_mul_f32 v48, v54, v34
    v_mul_f32 v49, v55, v34
    v_mul_f32 v56, v62, v34
    v_mul_f32 v57, v63, v34
    ds_write_addtid_b32 v73 offset:4624
    ds_write_addtid_b32 v74 offset:4896
    v_fma_f32 v48, -v55, v35, v48
    v_fmac_f32 v49, v54, v35
    v_fma_f32 v56, -v63, v35, v56
    v_fmac_f32 v57, v62, v35
    v_cvt_pk_bf16_f32 v75, v48, -v49
    v_cvt_pk_bf16_f32 v72, v56, -v57
    v_mul_f32 v38, v48, v34
    v_mul_f32 v39, v49, v34
    v_mul_f32 v40, v56, v34
    v_mul_f32 v41, v57, v34
    ds_write_addtid_b32 v75 offset:5168
    ds_write_addtid_b32 v72 offset:5440
    v_fma_f32 v38, -v49, v35, v38
    v_fmac_f32 v39, v48, v35
    v_fma_f32 v40, -v57, v35, v40
    v_fmac_f32 v41, v56, v35
    v_cvt_pk_bf16_f32 v73, v38, -v39
    v_cvt_pk_bf16_f32 v74, v40, -v41
    v_mul_f32 v46, v38, v34
    v_mul_f32 v47, v39, v34
    v_mul_f32 v50, v40, v34
    v_mul_f32 v51, v41, v34
    ds_write_addtid_b32 v73 offset:5712
    ds_write_addtid_b32 v74 offset:5984
    v_fma_f32 v46, -v39, v35, v46
    v_fmac_f32 v47, v38, v35
    v_fma_f32 v50, -v41, v35, v50
    v_fmac_f32 v51, v40, v35
    v_cvt_pk_bf16_f32 v75, v46, -v47
    v_cvt_pk_bf16_f32 v72, v50, -v51
    v_mul_f32 v54, v46, v34
    v_mul_f32 v55, v47, v34
    v_mul_f32 v62, v50, v34
    v_mul_f32 v63, v51, v34
    ds_write_addtid_b32 v75 offset:6256
    ds_write_addtid_b32 v72 offset:6528
    v_fma_f32 v54, -v47, v35, v54
    v_fmac_f32 v55, v46, v35
    v_fma_f32 v62, -v51, v35, v62
    v_fmac_f32 v63, v50, v35
    v_cvt_pk_bf16_f32 v73, v54, -v55
    v_cvt_pk_bf16_f32 v74, v62, -v63
    ds_write_addtid_b32 v73 offset:6800
    ds_write_addtid_b32 v74 offset:7072
    s_barrier
    ds_read_b128 v[76:79], v8 offset:0
    ds_read_b128 v[108:111], v9 offset:0
    ds_read_b128 v[80:83], v8 offset:32
    ds_read_b128 v[112:115], v9 offset:32
    ds_read_b128 v[84:87], v8 offset:64
    ds_read_b128 v[116:119], v9 offset:64
    ds_read_b128 v[88:91], v8 offset:96
    ds_read_b128 v[120:123], v9 offset:96
    ds_read_b128 v[92:95], v8 offset:128
    ds_read_b128 v[124:127], v9 offset:128
    ds_read_b128 v[96:99], v8 offset:160
    ds_read_b128 v[128:131], v9 offset:160
    ds_read_b128 v[100:103], v8 offset:192
    ds_read_b128 v[132:135], v9 offset:192
    ds_read_b128 v[104:107], v8 offset:224
    ds_read_b128 v[136:139], v9 offset:224
    v_subrev_u32 v9, 16624, v9
    v_lshrrev_b32 v18, 16, v18
    v_lshrrev_b32 v19, 16, v19
    v_lshrrev_b32 v20, 16, v20
    v_lshrrev_b32 v21, 16, v21
    v_lshrrev_b32 v22, 16, v22
    v_lshrrev_b32 v23, 16, v23
    s_cmp_lg_u32 s69, 0
    s_cbranch_scc1 L_kacc_27
    v_mov_b32 v140, 0
    v_mov_b32 v141, 0
    v_mov_b32 v142, 0
    v_mov_b32 v143, 0
    v_mov_b32 v144, 0
    v_mov_b32 v145, 0
    v_mov_b32 v146, 0
    v_mov_b32 v147, 0
    v_mov_b32 v148, 0
    v_mov_b32 v149, 0
    v_mov_b32 v150, 0
    v_mov_b32 v151, 0
    v_mov_b32 v152, 0
    v_mov_b32 v153, 0
    v_mov_b32 v154, 0
    v_mov_b32 v155, 0
L_kacc_27:
    s_waitcnt lgkmcnt(14)
    s_nop 0
    v_mfma_f32_32x32x16_bf16 v[140:155], v[76:79], v[108:111], v[140:155]
    s_waitcnt lgkmcnt(12)
    v_mfma_f32_32x32x16_bf16 v[140:155], v[80:83], v[112:115], v[140:155]
    s_waitcnt lgkmcnt(10)
    v_mfma_f32_32x32x16_bf16 v[140:155], v[84:87], v[116:119], v[140:155]
    s_waitcnt lgkmcnt(8)
    v_mfma_f32_32x32x16_bf16 v[140:155], v[88:91], v[120:123], v[140:155]
    s_waitcnt lgkmcnt(6)
    v_mfma_f32_32x32x16_bf16 v[140:155], v[92:95], v[124:127], v[140:155]
    s_waitcnt lgkmcnt(4)
    v_mfma_f32_32x32x16_bf16 v[140:155], v[96:99], v[128:131], v[140:155]
    s_waitcnt lgkmcnt(2)
    v_mfma_f32_32x32x16_bf16 v[140:155], v[100:103], v[132:135], v[140:155]
    s_waitcnt lgkmcnt(0)
    v_mfma_f32_32x32x16_bf16 v[140:155], v[104:107], v[136:139], v[140:155]
    s_add_u32 s69, s69, 1
    s_cmp_lt_u32 s69, 2
    s_cbranch_scc1 L_kpass_26
    v_cndmask_b32 v25, 0, v25, s[74:75]
    s_nop 9
    v_add_f32 v140, v140, v25
    v_cvt_pk_bf16_f32 v156, v147, v146
    v_cvt_pk_bf16_f32 v157, v145, v144
    v_cvt_pk_bf16_f32 v158, v143, v142
    v_cvt_pk_bf16_f32 v159, v141, v140
    ds_write_b128 v13, v[156:159] offset:4224
    v_cvt_pk_bf16_f32 v2, v148, v149
    v_cvt_pk_bf16_f32 v160, v150, v150
    v_cvt_pk_bf16_f32 v163, v148, v148
    v_perm_b32 v161, v160, v2, v10
    v_perm_b32 v162, v160, v2, v11
    ds_write_b128 v14, v[160:163] offset:4736
    v_cvt_pk_bf16_f32 v2, v151, v152
    v_cvt_pk_bf16_f32 v164, v153, v153
    v_cvt_pk_bf16_f32 v167, v151, v151
    v_perm_b32 v165, v164, v2, v10
    v_perm_b32 v166, v164, v2, v11
    ds_write_b128 v14, v[164:167] offset:4224
    v_cvt_pk_bf16_f32 v168, v155, v155
    v_cvt_pk_bf16_f32 v170, v154, v154
    v_cvt_pk_bf16_f32 v171, v154, v154
    v_perm_b32 v169, v168, v170, v12
    v_mov_b32 v144, 0
    v_mov_b32 v145, 0
    ds_write_b128 v15, v[168:171] offset:4224
    ds_write_b32 v17, v144 offset:4096
    ds_read_b32 v2, v13 offset:4240
    ds_read_b32 v3, v14 offset:4752
    ds_read_b32 v4, v14 offset:4240
    ds_read_b32 v5, v15 offset:4240
    v_alignbit_b32 v76, v157, v156, 16
    v_alignbit_b32 v77, v158, v157, 16
    v_alignbit_b32 v78, v159, v158, 16
    s_waitcnt lgkmcnt(0)
    v_alignbit_b32 v79, v2, v159, 16
    ds_write_b128 v13, v[76:79] offset:0
    v_alignbit_b32 v80, v161, v160, 16
    v_alignbit_b32 v81, v162, v161, 16
    v_alignbit_b32 v82, v163, v162, 16
    v_alignbit_b32 v83, v3, v163, 16
    ds_write_b128 v14, v[80:83] offset:512
    v_alignbit_b32 v84, v165, v164, 16
    v_alignbit_b32 v85, v166, v165, 16
    v_alignbit_b32 v86, v167, v166, 16
    v_alignbit_b32 v87, v4, v167, 16
    ds_write_b128 v14, v[84:87] offset:0
    v_alignbit_b32 v88, v169, v168, 16
    v_alignbit_b32 v89, v170, v169, 16
    v_alignbit_b32 v90, v171, v170, 16
    v_alignbit_b32 v91, v5, v171, 16
    ds_write_b128 v15, v[88:91] offset:0
    s_barrier
L_nb_29:
    v_mov_b32 v246, 0
    s_mov_b32 s87, 0
L_spin_30:
    global_load_dwordx2 v[250:251], v246, s[48:49] sc1
    s_waitcnt vmcnt(0)
    v_cmp_eq_u32 vcc, 0, v250
    s_add_u32 s87, s87, 1
    s_cbranch_vccz L_spun_31
    s_sleep 2
    s_cmp_lt_u32 s87, 65536
    s_cbranch_scc1 L_spin_30
L_spun_31:
    s_barrier
    s_barrier
    s_barrier
    s_barrier
    s_barrier
    s_barrier
L_nb_32:
    v_and_b32 v247, 31, v1
    v_lshlrev_b32 v247, 8, v247
    s_add_u32 s88, s93, s95
    s_cmp_ge_u32 s88, 288
    s_cselect_b32 s88, 128, 0
    s_add_u32 s88, s88, 14573568
    s_mov_b32 s87, 0
L_spin_33:
    buffer_load_dwordx2 v[244:245], v247, s[16:19], s88 offen sc1
    s_waitcnt vmcnt(0)
    v_cmp_ne_u64 vcc, v[250:251], v[244:245]
    s_add_u32 s87, s87, 1
    s_cbranch_vccz L_spun_34
    s_sleep 2
    s_cmp_lt_u32 s87, 65536
    s_cbranch_scc1 L_spin_33
L_spun_34:
    s_mul_i32 s70, s95, 25328
    s_add_u32 s70, s70, s92
    s_add_u32 s69, s93, s95
    v_lshlrev_b32 v196, 4, v1
    s_add_u32 m0, s70, 512
    s_lshl_b32 s69, s69, 12
    s_add_u32 s69, s69, 9568252
    buffer_load_dwordx4 v196, s[16:19], s69 offen sc1 lds
    buffer_load_dwordx4 v196, s[16:19], s69 offen offset:1024 sc1 lds
    buffer_load_dwordx4 v196, s[16:19], s69 offen offset:2048 sc1 lds
    buffer_load_dwordx4 v196, s[16:19], s69 offen offset:3072 sc1 lds
    s_add_u32 m0, s70, 5152
    s_add_u32 s69, s69, 4
    buffer_load_dwordx4 v196, s[16:19], s69 offen sc1 lds
    buffer_load_dwordx4 v196, s[16:19], s69 offen offset:1024 sc1 lds
    buffer_load_dwordx4 v196, s[16:19], s69 offen offset:2048 sc1 lds
    buffer_load_dwordx4 v196, s[16:19], s69 offen offset:3072 sc1 lds
    v_lshl_add_u32 v197, v1, 3, s70
    v_mov_b32 v198, 0
    v_mov_b32 v199, 0
    ds_write_b64 v197, v[198:199]
    ds_write_b64 v197, v[198:199] offset:4640
    v_mov_b32 v197, s70
    s_waitcnt lgkmcnt(0)
    s_barrier
    s_waitcnt vmcnt(0)
    ds_write_b32 v197, v198 offset:512
    ds_write_b32 v195, v255
L_join:
    s_lshr_b32 s66, s3, 1
    s_add_u32 s64, s93, s66
    s_mul_i32 s66, s66, 25328
    s_add_u32 s66, s66, s92
    s_and_b32 s67, s3, 1
    v_lshlrev_b32 v2, 4, v1
    v_and_b32 v3, 15, v1
    v_lshrrev_b32 v4, 4, v1
    v_and_b32 v5, 1, v1
    v_lshrrev_b32 v3, 1, v3
    s_lshl_b32 s71, s67, 8
    s_sub_u32 s71, s66, s71
    v_mul_u32_u24 v6, 4224, v5
    v_lshl_add_u32 v6, v4, 4, v6
    v_lshlrev_b32 v7, 3, v3
    v_sub_u32 v6, v6, v7
    v_add_u32 v6, 9608, v6
    v_add_u32 v8, s71, v6
    v_mul_u32_u24 v6, 4640, v5
    v_lshl_add_u32 v6, v4, 4, v6
    v_lshl_add_u32 v6, v3, 6, v6
    v_add_u32 v6, 320, v6
    v_add_u32 v9, s71, v6
    s_lshl_b32 s62, s60, 2
    s_lshr_b32 s63, s61, 3
    s_add_u32 s62, s62, s63
    s_and_b32 s63, s61, 7
    s_cmp_ge_u32 s3, 6
    s_cbranch_scc1 L_cload_37
    s_cmp_ge_u32 s3, s94
    s_cbranch_scc1 L_cidle_35
    s_lshr_b32 s68, s3, 1
    s_lshl_b32 s68, s68, 2
    s_add_u32 s68, s68, 163744
    v_mov_b32 v12, s68
L_uw_39:
    ds_read_b32 v14, v12
    s_waitcnt lgkmcnt(0)
    v_cmp_eq_u32 vcc, 0, v14
    s_nop 0
    s_cbranch_vccnz L_uw_39
    s_lshl_b32 s68, s3, 2
    s_add_u32 s68, s68, 163776
    v_mov_b32 v12, s68
    v_xor_b32 v13, 4, v12
    v_mov_b32 v14, 0
    ds_write_b32 v12, v14
    v_mov_b32 v15, 1
    ds_read_b128 v[108:111], v9 offset:3776
    ds_read_b64 v[16:17], v8 offset:3776
    ds_read_b64 v[18:19], v8 offset:3784
    ds_read_b128 v[104:107], v9 offset:3264
    ds_read_b64 v[20:21], v8 offset:3264
    ds_read_b64 v[22:23], v8 offset:3272
    ds_read_b128 v[100:103], v9 offset:2752
    ds_read_b64 v[24:25], v8 offset:2752
    ds_read_b64 v[26:27], v8 offset:2760
    ds_read_b128 v[96:99], v9 offset:2240
    ds_read_b64 v[28:29], v8 offset:2240
    ds_read_b64 v[30:31], v8 offset:2248
    ds_read_b128 v[92:95], v9 offset:1728
    ds_read_b64 v[32:33], v8 offset:1728
    ds_read_b64 v[34:35], v8 offset:1736
    ds_read_b128 v[88:91], v9 offset:1216
    ds_read_b64 v[36:37], v8 offset:1216
    ds_read_b64 v[38:39], v8 offset:1224
    ds_read_b128 v[84:87], v9 offset:704
    ds_read_b64 v[40:41], v8 offset:704
    ds_read_b64 v[42:43], v8 offset:712
    ds_read_b128 v[80:83], v9 offset:192
    ds_read_b64 v[44:45], v8 offset:192
    ds_read_b64 v[46:47], v8 offset:200
    s_waitcnt lgkmcnt(0)
    v_mfma_f32_16x16x32_bf16 v[172:175], v[16:19], v[108:111], 0
    v_mfma_f32_16x16x32_bf16 v[168:171], v[16:19], v[104:107], 0
    ds_read_b128 v[140:143], v9 offset:3712
    v_mfma_f32_16x16x32_bf16 v[164:167], v[16:19], v[100:103], 0
    ds_read_b64 v[48:49], v8 offset:3712
    v_mfma_f32_16x16x32_bf16 v[160:163], v[16:19], v[96:99], 0
    ds_read_b64 v[50:51], v8 offset:3720
    v_mfma_f32_16x16x32_bf16 v[156:159], v[16:19], v[92:95], 0
    ds_read_b128 v[136:139], v9 offset:3200
    v_mfma_f32_16x16x32_bf16 v[152:155], v[16:19], v[88:91], 0
    ds_read_b64 v[52:53], v8 offset:3200
    v_mfma_f32_16x16x32_bf16 v[148:151], v[16:19], v[84:87], 0
    ds_read_b64 v[54:55], v8 offset:3208
    v_mfma_f32_16x16x32_bf16 v[144:147], v[16:19], v[80:83], 0
    ds_read_b128 v[132:135], v9 offset:2688
    v_mfma_f32_16x16x32_bf16 v[172:175], v[20:23], v[104:107], v[172:175]
    ds_read_b64 v[56:57], v8 offset:2688
    v_mfma_f32_16x16x32_bf16 v[168:171], v[20:23], v[100:103], v[168:171]
    ds_read_b64 v[58:59], v8 offset:2696
    v_mfma_f32_16x16x32_bf16 v[164:167], v[20:23], v[96:99], v[164:167]
    ds_read_b128 v[128:131], v9 offset:2176
    v_mfma_f32_16x16x32_bf16 v[160:163], v[20:23], v[92:95], v[160:163]
    ds_read_b64 v[60:61], v8 offset:2176
    v_mfma_f32_16x16x32_bf16 v[156:159], v[20:23], v[88:91], v[156:159]
    ds_read_b64 v[62:63], v8 offset:2184
    v_mfma_f32_16x16x32_bf16 v[152:155], v[20:23], v[84:87], v[152:155]
    v_mfma_f32_16x16x32_bf16 v[148:151], v[20:23], v[80:83], v[148:151]
    ds_read_b128 v[124:127], v9 offset:1664
    v_mfma_f32_16x16x32_bf16 v[172:175], v[24:27], v[100:103], v[172:175]
    ds_read_b64 v[64:65], v8 offset:1664
    v_mfma_f32_16x16x32_bf16 v[168:171], v[24:27], v[96:99], v[168:171]
    ds_read_b64 v[66:67], v8 offset:1672
    v_mfma_f32_16x16x32_bf16 v[164:167], v[24:27], v[92:95], v[164:167]
    ds_read_b128 v[120:123], v9 offset:1152
    v_mfma_f32_16x16x32_bf16 v[160:163], v[24:27], v[88:91], v[160:163]
    ds_read_b64 v[68:69], v8 offset:1152
    v_mfma_f32_16x16x32_bf16 v[156:159], v[24:27], v[84:87], v[156:159]
    ds_read_b64 v[70:71], v8 offset:1160
    v_mfma_f32_16x16x32_bf16 v[152:155], v[24:27], v[80:83], v[152:155]
    ds_read_b128 v[116:119], v9 offset:640
    v_mfma_f32_16x16x32_bf16 v[172:175], v[28:31], v[96:99], v[172:175]
    ds_read_b64 v[72:73], v8 offset:640
    v_mfma_f32_16x16x32_bf16 v[168:171], v[28:31], v[92:95], v[168:171]
    ds_read_b64 v[74:75], v8 offset:648
    v_mfma_f32_16x16x32_bf16 v[164:167], v[28:31], v[88:91], v[164:167]
    ds_read_b128 v[112:115], v9 offset:128
    v_mfma_f32_16x16x32_bf16 v[160:163], v[28:31], v[84:87], v[160:163]
    ds_read_b64 v[76:77], v8 offset:128
    v_mfma_f32_16x16x32_bf16 v[156:159], v[28:31], v[80:83], v[156:159]
    ds_read_b64 v[78:79], v8 offset:136
    v_mfma_f32_16x16x32_bf16 v[172:175], v[32:35], v[92:95], v[172:175]
    v_mfma_f32_16x16x32_bf16 v[168:171], v[32:35], v[88:91], v[168:171]
    v_mfma_f32_16x16x32_bf16 v[164:167], v[32:35], v[84:87], v[164:167]
    v_mfma_f32_16x16x32_bf16 v[160:163], v[32:35], v[80:83], v[160:163]
    v_mfma_f32_16x16x32_bf16 v[172:175], v[36:39], v[88:91], v[172:175]
    v_mfma_f32_16x16x32_bf16 v[168:171], v[36:39], v[84:87], v[168:171]
    v_mfma_f32_16x16x32_bf16 v[164:167], v[36:39], v[80:83], v[164:167]
    v_mfma_f32_16x16x32_bf16 v[172:175], v[40:43], v[84:87], v[172:175]
    v_mfma_f32_16x16x32_bf16 v[168:171], v[40:43], v[80:83], v[168:171]
    v_mfma_f32_16x16x32_bf16 v[172:175], v[44:47], v[80:83], v[172:175]
    s_waitcnt lgkmcnt(0)
    s_waitcnt vmcnt(0)
    s_barrier
    v_mfma_f32_16x16x32_bf16 v[172:175], v[48:51], v[140:143], v[172:175]
    v_mfma_f32_16x16x32_bf16 v[168:171], v[48:51], v[136:139], v[168:171]
    ds_read_b128 v[108:111], v9 offset:3648
    v_mfma_f32_16x16x32_bf16 v[164:167], v[48:51], v[132:135], v[164:167]
    ds_read_b64 v[16:17], v8 offset:3648
    v_mfma_f32_16x16x32_bf16 v[160:163], v[48:51], v[128:131], v[160:163]
    ds_read_b64 v[18:19], v8 offset:3656
    v_mfma_f32_16x16x32_bf16 v[156:159], v[48:51], v[124:127], v[156:159]
    ds_read_b128 v[104:107], v9 offset:3136
    v_mfma_f32_16x16x32_bf16 v[152:155], v[48:51], v[120:123], v[152:155]
    ds_read_b64 v[20:21], v8 offset:3136
    v_mfma_f32_16x16x32_bf16 v[148:151], v[48:51], v[116:119], v[148:151]
    ds_read_b64 v[22:23], v8 offset:3144
    v_mfma_f32_16x16x32_bf16 v[144:147], v[48:51], v[112:115], v[144:147]
    ds_read_b128 v[100:103], v9 offset:2624
    v_mfma_f32_16x16x32_bf16 v[172:175], v[52:55], v[136:139], v[172:175]
    ds_read_b64 v[24:25], v8 offset:2624
    v_mfma_f32_16x16x32_bf16 v[168:171], v[52:55], v[132:135], v[168:171]
    ds_read_b64 v[26:27], v8 offset:2632
    v_mfma_f32_16x16x32_bf16 v[164:167], v[52:55], v[128:131], v[164:167]
    ds_read_b128 v[96:99], v9 offset:2112
    v_mfma_f32_16x16x32_bf16 v[160:163], v[52:55], v[124:127], v[160:163]
    ds_read_b64 v[28:29], v8 offset:2112
    v_mfma_f32_16x16x32_bf16 v[156:159], v[52:55], v[120:123], v[156:159]
    ds_read_b64 v[30:31], v8 offset:2120
    v_mfma_f32_16x16x32_bf16 v[152:155], v[52:55], v[116:119], v[152:155]
    v_mfma_f32_16x16x32_bf16 v[148:151], v[52:55], v[112:115], v[148:151]
    ds_read_b128 v[92:95], v9 offset:1600
    v_mfma_f32_16x16x32_bf16 v[172:175], v[56:59], v[132:135], v[172:175]
    ds_read_b64 v[32:33], v8 offset:1600
    v_mfma_f32_16x16x32_bf16 v[168:171], v[56:59], v[128:131], v[168:171]
    ds_read_b64 v[34:35], v8 offset:1608
    v_mfma_f32_16x16x32_bf16 v[164:167], v[56:59], v[124:127], v[164:167]
    ds_read_b128 v[88:91], v9 offset:1088
    v_mfma_f32_16x16x32_bf16 v[160:163], v[56:59], v[120:123], v[160:163]
    ds_read_b64 v[36:37], v8 offset:1088
    v_mfma_f32_16x16x32_bf16 v[156:159], v[56:59], v[116:119], v[156:159]
    ds_read_b64 v[38:39], v8 offset:1096
    v_mfma_f32_16x16x32_bf16 v[152:155], v[56:59], v[112:115], v[152:155]
    ds_read_b128 v[84:87], v9 offset:576
    v_mfma_f32_16x16x32_bf16 v[172:175], v[60:63], v[128:131], v[172:175]
    ds_read_b64 v[40:41], v8 offset:576
    v_mfma_f32_16x16x32_bf16 v[168:171], v[60:63], v[124:127], v[168:171]
    ds_read_b64 v[42:43], v8 offset:584
    v_mfma_f32_16x16x32_bf16 v[164:167], v[60:63], v[120:123], v[164:167]
    ds_read_b128 v[80:83], v9 offset:64
    v_mfma_f32_16x16x32_bf16 v[160:163], v[60:63], v[116:119], v[160:163]
    ds_read_b64 v[44:45], v8 offset:64
    v_mfma_f32_16x16x32_bf16 v[156:159], v[60:63], v[112:115], v[156:159]
    ds_read_b64 v[46:47], v8 offset:72
    v_mfma_f32_16x16x32_bf16 v[172:175], v[64:67], v[124:127], v[172:175]
    v_mfma_f32_16x16x32_bf16 v[168:171], v[64:67], v[120:123], v[168:171]
    v_mfma_f32_16x16x32_bf16 v[164:167], v[64:67], v[116:119], v[164:167]
    v_mfma_f32_16x16x32_bf16 v[160:163], v[64:67], v[112:115], v[160:163]
    v_mfma_f32_16x16x32_bf16 v[172:175], v[68:71], v[120:123], v[172:175]
    v_mfma_f32_16x16x32_bf16 v[168:171], v[68:71], v[116:119], v[168:171]
    v_mfma_f32_16x16x32_bf16 v[164:167], v[68:71], v[112:115], v[164:167]
    v_mfma_f32_16x16x32_bf16 v[172:175], v[72:75], v[116:119], v[172:175]
    v_mfma_f32_16x16x32_bf16 v[168:171], v[72:75], v[112:115], v[168:171]
    v_mfma_f32_16x16x32_bf16 v[172:175], v[76:79], v[112:115], v[172:175]
    s_waitcnt lgkmcnt(0)
    v_mfma_f32_16x16x32_bf16 v[172:175], v[16:19], v[108:111], v[172:175]
    v_mfma_f32_16x16x32_bf16 v[168:171], v[16:19], v[104:107], v[168:171]
    ds_read_b128 v[140:143], v9 offset:3584
    v_mfma_f32_16x16x32_bf16 v[164:167], v[16:19], v[100:103], v[164:167]
    ds_read_b64 v[48:49], v8 offset:3584
    v_mfma_f32_16x16x32_bf16 v[160:163], v[16:19], v[96:99], v[160:163]
    ds_read_b64 v[50:51], v8 offset:3592
    v_mfma_f32_16x16x32_bf16 v[156:159], v[16:19], v[92:95], v[156:159]
    ds_read_b128 v[136:139], v9 offset:3072
    v_mfma_f32_16x16x32_bf16 v[152:155], v[16:19], v[88:91], v[152:155]
    ds_read_b64 v[52:53], v8 offset:3072
    v_mfma_f32_16x16x32_bf16 v[148:151], v[16:19], v[84:87], v[148:151]
    ds_read_b64 v[54:55], v8 offset:3080
    v_mfma_f32_16x16x32_bf16 v[144:147], v[16:19], v[80:83], v[144:147]
    ds_read_b128 v[132:135], v9 offset:2560
    v_mfma_f32_16x16x32_bf16 v[172:175], v[20:23], v[104:107], v[172:175]
    ds_read_b64 v[56:57], v8 offset:2560
    v_mfma_f32_16x16x32_bf16 v[168:171], v[20:23], v[100:103], v[168:171]
    ds_read_b64 v[58:59], v8 offset:2568
    v_mfma_f32_16x16x32_bf16 v[164:167], v[20:23], v[96:99], v[164:167]
    ds_read_b128 v[128:131], v9 offset:2048
    v_mfma_f32_16x16x32_bf16 v[160:163], v[20:23], v[92:95], v[160:163]
    ds_read_b64 v[60:61], v8 offset:2048
    v_mfma_f32_16x16x32_bf16 v[156:159], v[20:23], v[88:91], v[156:159]
    ds_read_b64 v[62:63], v8 offset:2056
    v_mfma_f32_16x16x32_bf16 v[152:155], v[20:23], v[84:87], v[152:155]
    v_mfma_f32_16x16x32_bf16 v[148:151], v[20:23], v[80:83], v[148:151]
    ds_read_b128 v[124:127], v9 offset:1536
    v_mfma_f32_16x16x32_bf16 v[172:175], v[24:27], v[100:103], v[172:175]
    ds_read_b64 v[64:65], v8 offset:1536
    v_mfma_f32_16x16x32_bf16 v[168:171], v[24:27], v[96:99], v[168:171]
    ds_read_b64 v[66:67], v8 offset:1544
    v_mfma_f32_16x16x32_bf16 v[164:167], v[24:27], v[92:95], v[164:167]
    ds_read_b128 v[120:123], v9 offset:1024
    v_mfma_f32_16x16x32_bf16 v[160:163], v[24:27], v[88:91], v[160:163]
    ds_read_b64 v[68:69], v8 offset:1024
    v_mfma_f32_16x16x32_bf16 v[156:159], v[24:27], v[84:87], v[156:159]
    ds_read_b64 v[70:71], v8 offset:1032
    v_mfma_f32_16x16x32_bf16 v[152:155], v[24:27], v[80:83], v[152:155]
    ds_read_b128 v[116:119], v9 offset:512
    v_mfma_f32_16x16x32_bf16 v[172:175], v[28:31], v[96:99], v[172:175]
    ds_read_b64 v[72:73], v8 offset:512
    v_mfma_f32_16x16x32_bf16 v[168:171], v[28:31], v[92:95], v[168:171]
    ds_read_b64 v[74:75], v8 offset:520
    v_mfma_f32_16x16x32_bf16 v[164:167], v[28:31], v[88:91], v[164:167]
    ds_read_b128 v[112:115], v9 offset:0
    v_mfma_f32_16x16x32_bf16 v[160:163], v[28:31], v[84:87], v[160:163]
    ds_read_b64 v[76:77], v8 offset:0
    v_mfma_f32_16x16x32_bf16 v[156:159], v[28:31], v[80:83], v[156:159]
    ds_read_b64 v[78:79], v8 offset:8
    v_mfma_f32_16x16x32_bf16 v[172:175], v[32:35], v[92:95], v[172:175]
    v_mfma_f32_16x16x32_bf16 v[168:171], v[32:35], v[88:91], v[168:171]
    v_mfma_f32_16x16x32_bf16 v[164:167], v[32:35], v[84:87], v[164:167]
    v_mfma_f32_16x16x32_bf16 v[160:163], v[32:35], v[80:83], v[160:163]
    v_mfma_f32_16x16x32_bf16 v[172:175], v[36:39], v[88:91], v[172:175]
    v_mfma_f32_16x16x32_bf16 v[168:171], v[36:39], v[84:87], v[168:171]
    v_mfma_f32_16x16x32_bf16 v[164:167], v[36:39], v[80:83], v[164:167]
    v_mfma_f32_16x16x32_bf16 v[172:175], v[40:43], v[84:87], v[172:175]
    v_mfma_f32_16x16x32_bf16 v[168:171], v[40:43], v[80:83], v[168:171]
    v_mfma_f32_16x16x32_bf16 v[172:175], v[44:47], v[80:83], v[172:175]
    s_waitcnt lgkmcnt(0)
    v_mfma_f32_16x16x32_bf16 v[172:175], v[48:51], v[140:143], v[172:175]
    v_mfma_f32_16x16x32_bf16 v[168:171], v[48:51], v[136:139], v[168:171]
    v_mfma_f32_16x16x32_bf16 v[164:167], v[48:51], v[132:135], v[164:167]
    v_mfma_f32_16x16x32_bf16 v[160:163], v[48:51], v[128:131], v[160:163]
    v_mfma_f32_16x16x32_bf16 v[156:159], v[48:51], v[124:127], v[156:159]
    v_mfma_f32_16x16x32_bf16 v[152:155], v[48:51], v[120:123], v[152:155]
    v_mfma_f32_16x16x32_bf16 v[148:151], v[48:51], v[116:119], v[148:151]
    v_mfma_f32_16x16x32_bf16 v[144:147], v[48:51], v[112:115], v[144:147]
    v_mfma_f32_16x16x32_bf16 v[172:175], v[52:55], v[136:139], v[172:175]
    v_mfma_f32_16x16x32_bf16 v[168:171], v[52:55], v[132:135], v[168:171]
    v_mfma_f32_16x16x32_bf16 v[164:167], v[52:55], v[128:131], v[164:167]
    v_mfma_f32_16x16x32_bf16 v[160:163], v[52:55], v[124:127], v[160:163]
    v_mfma_f32_16x16x32_bf16 v[156:159], v[52:55], v[120:123], v[156:159]
    v_mfma_f32_16x16x32_bf16 v[152:155], v[52:55], v[116:119], v[152:155]
    v_mfma_f32_16x16x32_bf16 v[148:151], v[52:55], v[112:115], v[148:151]
    v_mfma_f32_16x16x32_bf16 v[172:175], v[56:59], v[132:135], v[172:175]
    v_mfma_f32_16x16x32_bf16 v[168:171], v[56:59], v[128:131], v[168:171]
    v_mfma_f32_16x16x32_bf16 v[164:167], v[56:59], v[124:127], v[164:167]
    v_mfma_f32_16x16x32_bf16 v[160:163], v[56:59], v[120:123], v[160:163]
    v_mfma_f32_16x16x32_bf16 v[156:159], v[56:59], v[116:119], v[156:159]
    v_mfma_f32_16x16x32_bf16 v[152:155], v[56:59], v[112:115], v[152:155]
    v_mfma_f32_16x16x32_bf16 v[172:175], v[60:63], v[128:131], v[172:175]
    v_mfma_f32_16x16x32_bf16 v[168:171], v[60:63], v[124:127], v[168:171]
    v_mfma_f32_16x16x32_bf16 v[164:167], v[60:63], v[120:123], v[164:167]
    v_mfma_f32_16x16x32_bf16 v[160:163], v[60:63], v[116:119], v[160:163]
    v_mfma_f32_16x16x32_bf16 v[156:159], v[60:63], v[112:115], v[156:159]
    v_mfma_f32_16x16x32_bf16 v[172:175], v[64:67], v[124:127], v[172:175]
    v_mfma_f32_16x16x32_bf16 v[168:171], v[64:67], v[120:123], v[168:171]
    v_mfma_f32_16x16x32_bf16 v[164:167], v[64:67], v[116:119], v[164:167]
    v_mfma_f32_16x16x32_bf16 v[160:163], v[64:67], v[112:115], v[160:163]
    v_mfma_f32_16x16x32_bf16 v[172:175], v[68:71], v[120:123], v[172:175]
    v_mfma_f32_16x16x32_bf16 v[168:171], v[68:71], v[116:119], v[168:171]
    v_mfma_f32_16x16x32_bf16 v[164:167], v[68:71], v[112:115], v[164:167]
    v_mfma_f32_16x16x32_bf16 v[172:175], v[72:75], v[116:119], v[172:175]
    v_mfma_f32_16x16x32_bf16 v[168:171], v[72:75], v[112:115], v[168:171]
    v_mfma_f32_16x16x32_bf16 v[172:175], v[76:79], v[112:115], v[172:175]
    s_lshl_b32 s68, s3, 12
    s_xor_b32 s69, s68, 4096
    v_add_u32 v2, 49152, v2
    v_add_u32 v3, s69, v2
    v_add_u32 v2, s68, v2
    v_and_b32 v4, 15, v1
    v_lshrrev_b32 v5, 4, v1
    v_lshlrev_b32 v4, 5, v4
    v_lshl_add_u32 v4, v5, 3, v4
    s_lshl_b32 s68, s64, 12
    s_add_u32 s68, s68, 11927552
    s_cmp_eq_u32 s67, 1
    s_cbranch_scc1 L_c1_36
    ds_write_b128 v2, v[148:151] offset:0
    ds_write_b128 v2, v[156:159] offset:1024
    ds_write_b128 v2, v[164:167] offset:2048
    ds_write_b128 v2, v[172:175] offset:3072
    ds_write_b32 v12, v15
L_xw_40:
    ds_read_b32 v14, v13
    s_waitcnt lgkmcnt(0)
    v_cmp_eq_u32 vcc, 0, v14
    s_nop 0
    s_cbranch_vccnz L_xw_40
    ds_read_b128 v[16:19], v3 offset:0
    ds_read_b128 v[20:23], v3 offset:1024
    ds_read_b128 v[24:27], v3 offset:2048
    ds_read_b128 v[28:31], v3 offset:3072
    s_waitcnt lgkmcnt(3)
    v_add_f32 v144, v144, v16
    v_add_f32 v145, v145, v17
    v_add_f32 v146, v146, v18
    v_add_f32 v147, v147, v19
    v_cvt_pk_bf16_f32 v80, v144, v145
    v_cvt_pk_bf16_f32 v81, v146, v147
    buffer_store_dwordx2 v[80:81], v4, s[16:19], s68 offen offset:0 sc1
    s_waitcnt lgkmcnt(2)
    v_add_f32 v152, v152, v20
    v_add_f32 v153, v153, v21
    v_add_f32 v154, v154, v22
    v_add_f32 v155, v155, v23
    v_cvt_pk_bf16_f32 v84, v152, v153
    v_cvt_pk_bf16_f32 v85, v154, v155
    buffer_store_dwordx2 v[84:85], v4, s[16:19], s68 offen offset:1024 sc1
    s_waitcnt lgkmcnt(1)
    v_add_f32 v160, v160, v24
    v_add_f32 v161, v161, v25
    v_add_f32 v162, v162, v26
    v_add_f32 v163, v163, v27
    v_cvt_pk_bf16_f32 v88, v160, v161
    v_cvt_pk_bf16_f32 v89, v162, v163
    buffer_store_dwordx2 v[88:89], v4, s[16:19], s68 offen offset:2048 sc1
    s_waitcnt lgkmcnt(0)
    v_add_f32 v168, v168, v28
    v_add_f32 v169, v169, v29
    v_add_f32 v170, v170, v30
    v_add_f32 v171, v171, v31
    v_cvt_pk_bf16_f32 v92, v168, v169
    v_cvt_pk_bf16_f32 v93, v170, v171
    buffer_store_dwordx2 v[92:93], v4, s[16:19], s68 offen offset:3072 sc1
    s_branch L_cend_38
L_c1_36:
    ds_write_b128 v2, v[144:147] offset:0
    ds_write_b128 v2, v[152:155] offset:1024
    ds_write_b128 v2, v[160:163] offset:2048
    ds_write_b128 v2, v[168:171] offset:3072
    ds_write_b32 v12, v15
L_xw_41:
    ds_read_b32 v14, v13
    s_waitcnt lgkmcnt(0)
    v_cmp_eq_u32 vcc, 0, v14
    s_nop 0
    s_cbranch_vccnz L_xw_41
    ds_read_b128 v[16:19], v3 offset:0
    ds_read_b128 v[20:23], v3 offset:1024
    ds_read_b128 v[24:27], v3 offset:2048
    ds_read_b128 v[28:31], v3 offset:3072
    s_waitcnt lgkmcnt(3)
    v_add_f32 v148, v148, v16
    v_add_f32 v149, v149, v17
    v_add_f32 v150, v150, v18
    v_add_f32 v151, v151, v19
    v_cvt_pk_bf16_f32 v80, v148, v149
    v_cvt_pk_bf16_f32 v81, v150, v151
    buffer_store_dwordx2 v[80:81], v4, s[16:19], s68 offen offset:512 sc1
    s_waitcnt lgkmcnt(2)
    v_add_f32 v156, v156, v20
    v_add_f32 v157, v157, v21
    v_add_f32 v158, v158, v22
    v_add_f32 v159, v159, v23
    v_cvt_pk_bf16_f32 v84, v156, v157
    v_cvt_pk_bf16_f32 v85, v158, v159
    buffer_store_dwordx2 v[84:85], v4, s[16:19], s68 offen offset:1536 sc1
    s_waitcnt lgkmcnt(1)
    v_add_f32 v164, v164, v24
    v_add_f32 v165, v165, v25
    v_add_f32 v166, v166, v26
    v_add_f32 v167, v167, v27
    v_cvt_pk_bf16_f32 v88, v164, v165
    v_cvt_pk_bf16_f32 v89, v166, v167
    buffer_store_dwordx2 v[88:89], v4, s[16:19], s68 offen offset:2560 sc1
    s_waitcnt lgkmcnt(0)
    v_add_f32 v172, v172, v28
    v_add_f32 v173, v173, v29
    v_add_f32 v174, v174, v30
    v_add_f32 v175, v175, v31
    v_cvt_pk_bf16_f32 v92, v172, v173
    v_cvt_pk_bf16_f32 v93, v174, v175
    buffer_store_dwordx2 v[92:93], v4, s[16:19], s68 offen offset:3584 sc1
    s_branch L_cend_38
L_cidle_35:
    s_waitcnt vmcnt(0)
    s_barrier
    s_cmp_lg_u32 s3, 5
    s_cbranch_scc1 L_fset_42
    v_mov_b32 v242, 0
    s_mov_b64 exec, 1
    buffer_store_dwordx2 v[250:251], v242, s[16:19], s84 offen sc1
    s_mov_b64 exec, -1
L_fset_42:
    s_branch L_cend_38
L_cload_37:
    s_barrier
L_cend_38:
    s_lshl_b32 s90, s60, 2
    s_and_b32 s91, s61, 3
    s_add_u32 s90, s90, s91
    s_lshr_b32 s91, s61, 2
    s_cmp_ge_u32 s3, 4
    s_cbranch_scc1 L_help_43
    s_mov_b32 s80, 4
    s_lshl_b32 s64, s3, 3
    s_lshl_b32 s64, 1, s64
    v_mov_b32 v19, s64
    v_mov_b32 v17, 163832
    v_cmp_eq_u32 s[70:71], 0, v1
    v_mov_b32 v18, 0x100000
    v_mov_b32 v6, 163828
    v_cndmask_b32 v18, v18, v6, s[70:71]
    s_mov_b32 s68, 0
    s_lshl_b32 s64, s63, 2
    s_add_u32 s64, s64, s3
    s_mul_i32 s65, s64, 73728
    s_lshl_b32 s66, s62, 9
    s_add_u32 s65, s65, s66
    s_add_u32 s82, s65, 7208960
    s_add_u32 s83, s82, 36864
    s_lshl_b32 s64, s64, 13
    s_lshl_b32 s66, s62, 8
    s_add_u32 s64, s64, s66
    s_add_u32 s81, s64, 14286848
    s_mov_b32 s69, 0x1f800000
    s_mov_b32 s76, 0x5f800000
    s_mov_b32 s77, 0x7e800000
    v_lshlrev_b32 v2, 4, v1
    s_lshl_b32 s64, s3, 11
    s_add_u32 s64, s64, 153728
    v_add_u32 v15, s64, v2
    v_and_b32 v6, 31, v1
    s_lshl_b32 s64, s3, 8
    s_add_u32 s64, s64, 161920
    v_lshl_add_u32 v16, v6, 3, s64
    v_lshlrev_b32 v3, 3, v1
    v_add_u32 v3, 8192, v3
    v_lshrrev_b32 v7, 5, v1
    v_cmp_lt_u32 s[72:73], 17, v6
    v_cmp_eq_u32 s[78:79], 18, v6
    v_cmp_lt_u32 s[70:71], 15, v6
    v_cmp_gt_u32 s[74:75], 32, v1
    s_andn2_b64 s[72:73], s[72:73], s[78:79]
    v_cndmask_b32 v6, v6, 18, s[78:79]
    v_lshlrev_b32 v6, 4, v6
    v_add_u32 v6, 9216, v6
    v_lshl_add_u32 v8, v7, 8, v6
    v_mul_u32_u24 v7, 48, v7
    v_add_u32 v7, v7, v6
    v_add_u32 v7, 768, v7
    v_cndmask_b32 v4, v8, v7, s[70:71]
    v_add_u32 v8, 512, v8
    v_add_u32 v7, 96, v7
    v_cndmask_b32 v5, v8, v7, s[70:71]
    v_mov_b32 v8, 0x100000
    v_cndmask_b32 v4, v4, v8, s[72:73]
    v_cndmask_b32 v5, v5, v8, s[72:73]
    v_bfe_u32 v10, v1, 4, 1
    v_and_b32 v8, 15, v1
    v_mul_u32_u24 v10, 18432, v10
    v_lshl_add_u32 v10, v8, 4, v10
    v_lshrrev_b32 v8, 5, v1
    v_lshl_add_u32 v13, v8, 8, v10
    v_lshlrev_b32 v14, 2, v1
    v_mov_b32 v33, 0
    v_mov_b32 v34, 0
    v_mov_b32 v37, 0
    v_mov_b32 v38, 0
    v_mov_b32 v41, 0
    v_mov_b32 v42, 0
    v_mov_b32 v45, 0
    v_mov_b32 v46, 0
    v_mov_b32 v120, 0
    v_mov_b32 v121, 0
    v_mov_b32 v122, 0
    v_mov_b32 v123, 0
    v_mov_b32 v124, 0
    v_mov_b32 v125, 0
    v_mov_b32 v126, 0
    v_mov_b32 v127, 0
    v_mov_b32 v128, 0
    v_mov_b32 v129, 0
    v_mov_b32 v130, 0
    v_mov_b32 v131, 0
    v_mov_b32 v132, 0
    v_mov_b32 v133, 0
    v_mov_b32 v134, 0
    v_mov_b32 v135, 0
    v_mov_b32 v136, 0
    v_mov_b32 v137, 0
    v_mov_b32 v138, 0
    v_mov_b32 v139, 0
    v_mov_b32 v140, 0
    v_mov_b32 v141, 0
    v_mov_b32 v142, 0
    v_mov_b32 v143, 0
    v_mov_b32 v144, 0
    v_mov_b32 v145, 0
    v_mov_b32 v146, 0
    v_mov_b32 v147, 0
    v_mov_b32 v148, 0
    v_mov_b32 v149, 0
    v_mov_b32 v150, 0
    v_mov_b32 v151, 0
    v_mov_b32 v68, 0
    v_mov_b32 v84, 0
    v_mov_b32 v69, 0
    v_mov_b32 v85, 0
    v_mov_b32 v70, 0
    v_mov_b32 v86, 0
    v_mov_b32 v71, 0
    v_mov_b32 v87, 0
    v_mov_b32 v78, 0
    v_mov_b32 v79, 0
    s_mov_b32 s67, 0
    v_mov_b32 v247, 0
    s_barrier
    ds_read_b64 v[76:77], v16
    ds_read_b128 v[24:27], v15
    ds_read_b128 v[28:31], v15 offset:1024
    s_waitcnt lgkmcnt(2)
    v_cndmask_b32 v32, 0, v76, s[74:75]
    v_cndmask_b32 v35, 0, v76, s[74:75]
    v_cndmask_b32 v36, v76, 0, s[74:75]
    v_cndmask_b32 v39, v76, 0, s[74:75]
    v_cndmask_b32 v40, 0, v77, s[74:75]
    v_cndmask_b32 v43, 0, v77, s[74:75]
    v_cndmask_b32 v44, v77, 0, s[74:75]
    v_cndmask_b32 v47, v77, 0, s[74:75]
    ds_read_b128 v[48:51], v2 offset:0
    ds_read_b64 v[72:73], v3 offset:0
    ds_read_b128 v[56:59], v4 offset:0
    ds_read_b128 v[52:55], v2 offset:1024
    ds_read_b128 v[64:67], v5 offset:0
    ds_read_b128 v[60:63], v4 offset:1216
    s_waitcnt lgkmcnt(3)
    v_mfma_f32_32x32x16_bf16 v[88:103], v[48:51], v[24:27], 0
    v_mfma_f32_32x32x8_bf16 v[88:103], v[72:73], v[32:33], v[88:103]
    s_nop 7
    s_nop 2
.p2align 6
L_aloop_59:
    v_mfma_f32_32x32x16_bf16 v[104:119], v[48:51], v[28:31], 0
    v_exp_f32 v76, v88
    v_cvt_pk_bf16_f32 v87, v78, v79
    v_exp_f32 v77, v89
    v_exp_f32 v78, v90
    v_cvt_pk_bf16_f32 v80, v76, v77
    v_exp_f32 v79, v91
    v_mfma_f32_32x32x8_bf16 v[104:119], v[72:73], v[40:41], v[104:119]
    v_exp_f32 v76, v92
    v_cvt_pk_bf16_f32 v81, v78, v79
    v_exp_f32 v77, v93
    v_exp_f32 v78, v94
    v_cvt_pk_bf16_f32 v82, v76, v77
    v_exp_f32 v79, v95
    v_mfma_f32_32x32x16_bf16 v[136:151], v[68:71], v[84:87], v[136:151]
    v_exp_f32 v76, v96
    v_cvt_pk_bf16_f32 v83, v78, v79
    v_exp_f32 v77, v97
    v_exp_f32 v78, v98
    v_cvt_pk_bf16_f32 v84, v76, v77
    v_exp_f32 v79, v99
    v_mfma_f32_32x32x16_bf16 v[120:135], v[56:59], v[80:83], v[120:135]
    s_waitcnt lgkmcnt(0)
    v_exp_f32 v76, v100
    v_cvt_pk_bf16_f32 v85, v78, v79
    v_exp_f32 v77, v101
    v_exp_f32 v78, v102
    v_cvt_pk_bf16_f32 v86, v76, v77
    v_exp_f32 v79, v103
    v_mfma_f32_32x32x16_bf16 v[88:103], v[52:55], v[24:27], 0
    ds_read_b128 v[48:51], v2 offset:2048
    v_exp_f32 v76, v104
    v_cvt_pk_bf16_f32 v87, v78, v79
    v_exp_f32 v77, v105
    v_exp_f32 v78, v106
    v_cvt_pk_bf16_f32 v80, v76, v77
    v_exp_f32 v79, v107
    v_mfma_f32_32x32x8_bf16 v[88:103], v[72:73], v[34:35], v[88:103]
    v_exp_f32 v76, v108
    v_cvt_pk_bf16_f32 v81, v78, v79
    v_exp_f32 v77, v109
    v_exp_f32 v78, v110
    v_cvt_pk_bf16_f32 v82, v76, v77
    v_exp_f32 v79, v111
    v_mfma_f32_32x32x16_bf16 v[120:135], v[64:67], v[84:87], v[120:135]
    ds_read_b128 v[68:71], v5 offset:1216
    v_exp_f32 v76, v112
    v_cvt_pk_bf16_f32 v83, v78, v79
    v_exp_f32 v77, v113
    v_exp_f32 v78, v114
    v_cvt_pk_bf16_f32 v84, v76, v77
    v_exp_f32 v79, v115
    v_mfma_f32_32x32x16_bf16 v[136:151], v[56:59], v[80:83], v[136:151]
    ds_read_b128 v[56:59], v4 offset:2432
    v_exp_f32 v76, v116
    v_cvt_pk_bf16_f32 v85, v78, v79
    v_exp_f32 v77, v117
    v_exp_f32 v78, v118
    v_cvt_pk_bf16_f32 v86, v76, v77
    v_exp_f32 v79, v119
    v_mfma_f32_32x32x16_bf16 v[104:119], v[52:55], v[28:31], 0
    v_exp_f32 v76, v88
    v_cvt_pk_bf16_f32 v87, v78, v79
    v_exp_f32 v77, v89
    v_exp_f32 v78, v90
    v_cvt_pk_bf16_f32 v80, v76, v77
    v_exp_f32 v79, v91
    v_mfma_f32_32x32x8_bf16 v[104:119], v[72:73], v[42:43], v[104:119]
    v_exp_f32 v76, v92
    v_cvt_pk_bf16_f32 v81, v78, v79
    v_exp_f32 v77, v93
    v_exp_f32 v78, v94
    v_cvt_pk_bf16_f32 v82, v76, v77
    v_exp_f32 v79, v95
    v_mfma_f32_32x32x16_bf16 v[136:151], v[64:67], v[84:87], v[136:151]
    v_exp_f32 v76, v96
    v_cvt_pk_bf16_f32 v83, v78, v79
    v_exp_f32 v77, v97
    v_exp_f32 v78, v98
    v_cvt_pk_bf16_f32 v84, v76, v77
    v_exp_f32 v79, v99
    v_mfma_f32_32x32x16_bf16 v[120:135], v[60:63], v[80:83], v[120:135]
    s_waitcnt lgkmcnt(0)
    v_exp_f32 v76, v100
    v_cvt_pk_bf16_f32 v85, v78, v79
    v_exp_f32 v77, v101
    v_exp_f32 v78, v102
    v_cvt_pk_bf16_f32 v86, v76, v77
    v_exp_f32 v79, v103
    v_mfma_f32_32x32x16_bf16 v[88:103], v[48:51], v[24:27], 0
    ds_read_b128 v[52:55], v2 offset:3072
    v_exp_f32 v76, v104
    v_cvt_pk_bf16_f32 v87, v78, v79
    v_exp_f32 v77, v105
    v_exp_f32 v78, v106
    v_cvt_pk_bf16_f32 v80, v76, v77
    v_exp_f32 v79, v107
    v_mfma_f32_32x32x8_bf16 v[88:103], v[72:73], v[36:37], v[88:103]
    ds_read_b64 v[74:75], v3 offset:512
    v_exp_f32 v76, v108
    v_cvt_pk_bf16_f32 v81, v78, v79
    v_exp_f32 v77, v109
    v_exp_f32 v78, v110
    v_cvt_pk_bf16_f32 v82, v76, v77
    v_exp_f32 v79, v111
    v_mfma_f32_32x32x16_bf16 v[120:135], v[68:71], v[84:87], v[120:135]
    ds_read_b128 v[64:67], v5 offset:2432
    v_exp_f32 v76, v112
    v_cvt_pk_bf16_f32 v83, v78, v79
    v_exp_f32 v77, v113
    v_exp_f32 v78, v114
    v_cvt_pk_bf16_f32 v84, v76, v77
    v_exp_f32 v79, v115
    v_mfma_f32_32x32x16_bf16 v[136:151], v[60:63], v[80:83], v[136:151]
    ds_read_b128 v[60:63], v4 offset:3648
    v_exp_f32 v76, v116
    v_cvt_pk_bf16_f32 v85, v78, v79
    v_exp_f32 v77, v117
    v_exp_f32 v78, v118
    v_cvt_pk_bf16_f32 v86, v76, v77
    v_exp_f32 v79, v119
    v_mfma_f32_32x32x16_bf16 v[104:119], v[48:51], v[28:31], 0
    v_exp_f32 v76, v88
    v_cvt_pk_bf16_f32 v87, v78, v79
    v_exp_f32 v77, v89
    v_exp_f32 v78, v90
    v_cvt_pk_bf16_f32 v80, v76, v77
    v_exp_f32 v79, v91
    v_mfma_f32_32x32x8_bf16 v[104:119], v[72:73], v[44:45], v[104:119]
    v_exp_f32 v76, v92
    v_cvt_pk_bf16_f32 v81, v78, v79
    v_exp_f32 v77, v93
    v_exp_f32 v78, v94
    v_cvt_pk_bf16_f32 v82, v76, v77
    v_exp_f32 v79, v95
    v_mfma_f32_32x32x16_bf16 v[136:151], v[68:71], v[84:87], v[136:151]
    v_exp_f32 v76, v96
    v_cvt_pk_bf16_f32 v83, v78, v79
    v_exp_f32 v77, v97
    v_exp_f32 v78, v98
    v_cvt_pk_bf16_f32 v84, v76, v77
    v_exp_f32 v79, v99
    v_mfma_f32_32x32x16_bf16 v[120:135], v[56:59], v[80:83], v[120:135]
    s_waitcnt lgkmcnt(0)
    v_exp_f32 v76, v100
    v_cvt_pk_bf16_f32 v85, v78, v79
    v_exp_f32 v77, v101
    v_exp_f32 v78, v102
    v_cvt_pk_bf16_f32 v86, v76, v77
    v_exp_f32 v79, v103
    v_mfma_f32_32x32x16_bf16 v[88:103], v[52:55], v[24:27], 0
    ds_read_b128 v[48:51], v2 offset:4096
    v_exp_f32 v76, v104
    v_cvt_pk_bf16_f32 v87, v78, v79
    v_exp_f32 v77, v105
    v_exp_f32 v78, v106
    v_cvt_pk_bf16_f32 v80, v76, v77
    v_exp_f32 v79, v107
    v_mfma_f32_32x32x8_bf16 v[88:103], v[72:73], v[38:39], v[88:103]
    v_exp_f32 v76, v108
    v_cvt_pk_bf16_f32 v81, v78, v79
    v_exp_f32 v77, v109
    v_exp_f32 v78, v110
    v_cvt_pk_bf16_f32 v82, v76, v77
    v_exp_f32 v79, v111
    v_mfma_f32_32x32x16_bf16 v[120:135], v[64:67], v[84:87], v[120:135]
    ds_read_b128 v[68:71], v5 offset:3648
    v_exp_f32 v76, v112
    v_cvt_pk_bf16_f32 v83, v78, v79
    v_exp_f32 v77, v113
    v_exp_f32 v78, v114
    v_cvt_pk_bf16_f32 v84, v76, v77
    v_exp_f32 v79, v115
    v_mfma_f32_32x32x16_bf16 v[136:151], v[56:59], v[80:83], v[136:151]
    ds_read_b128 v[56:59], v4 offset:4864
    v_exp_f32 v76, v116
    v_cvt_pk_bf16_f32 v85, v78, v79
    v_exp_f32 v77, v117
    v_exp_f32 v78, v118
    v_cvt_pk_bf16_f32 v86, v76, v77
    v_exp_f32 v79, v119
    v_mfma_f32_32x32x16_bf16 v[104:119], v[52:55], v[28:31], 0
    ds_read_b32 v20, v17
    v_exp_f32 v76, v88
    v_cvt_pk_bf16_f32 v87, v78, v79
    v_exp_f32 v77, v89
    v_exp_f32 v78, v90
    v_cvt_pk_bf16_f32 v80, v76, v77
    v_exp_f32 v79, v91
    v_mfma_f32_32x32x8_bf16 v[104:119], v[72:73], v[46:47], v[104:119]
    v_exp_f32 v76, v92
    v_cvt_pk_bf16_f32 v81, v78, v79
    v_exp_f32 v77, v93
    v_exp_f32 v78, v94
    v_cvt_pk_bf16_f32 v82, v76, v77
    v_exp_f32 v79, v95
    v_mfma_f32_32x32x16_bf16 v[136:151], v[64:67], v[84:87], v[136:151]
    v_exp_f32 v76, v96
    v_cvt_pk_bf16_f32 v83, v78, v79
    v_exp_f32 v77, v97
    v_exp_f32 v78, v98
    v_cvt_pk_bf16_f32 v84, v76, v77
    v_exp_f32 v79, v99
    v_mfma_f32_32x32x16_bf16 v[120:135], v[60:63], v[80:83], v[120:135]
    s_waitcnt lgkmcnt(0)
    v_exp_f32 v76, v100
    v_cvt_pk_bf16_f32 v85, v78, v79
    v_exp_f32 v77, v101
    v_exp_f32 v78, v102
    v_cvt_pk_bf16_f32 v86, v76, v77
    v_exp_f32 v79, v103
    v_mfma_f32_32x32x16_bf16 v[88:103], v[48:51], v[24:27], 0
    ds_read_b128 v[52:55], v2 offset:5120
    v_exp_f32 v76, v104
    v_cvt_pk_bf16_f32 v87, v78, v79
    v_exp_f32 v77, v105
    v_exp_f32 v78, v106
    v_cvt_pk_bf16_f32 v80, v76, v77
    v_exp_f32 v79, v107
    v_mfma_f32_32x32x8_bf16 v[88:103], v[74:75], v[32:33], v[88:103]
    v_exp_f32 v76, v108
    v_cvt_pk_bf16_f32 v81, v78, v79
    v_exp_f32 v77, v109
    v_exp_f32 v78, v110
    v_cvt_pk_bf16_f32 v82, v76, v77
    v_exp_f32 v79, v111
    v_mfma_f32_32x32x16_bf16 v[120:135], v[68:71], v[84:87], v[120:135]
    ds_read_b128 v[64:67], v5 offset:4864
    v_exp_f32 v76, v112
    v_cvt_pk_bf16_f32 v83, v78, v79
    v_exp_f32 v77, v113
    v_exp_f32 v78, v114
    v_cvt_pk_bf16_f32 v84, v76, v77
    v_exp_f32 v79, v115
    v_mfma_f32_32x32x16_bf16 v[136:151], v[60:63], v[80:83], v[136:151]
    ds_read_b128 v[60:63], v4 offset:6080
    v_exp_f32 v76, v116
    v_cvt_pk_bf16_f32 v85, v78, v79
    v_exp_f32 v77, v117
    v_exp_f32 v78, v118
    v_cvt_pk_bf16_f32 v86, v76, v77
    v_exp_f32 v79, v119
    v_mfma_f32_32x32x16_bf16 v[104:119], v[48:51], v[28:31], 0
    s_waitcnt vmcnt(0)
    v_exp_f32 v76, v88
    v_cvt_pk_bf16_f32 v87, v78, v79
    v_exp_f32 v77, v89
    v_exp_f32 v78, v90
    v_cvt_pk_bf16_f32 v80, v76, v77
    v_exp_f32 v79, v91
    v_mfma_f32_32x32x8_bf16 v[104:119], v[74:75], v[40:41], v[104:119]
    ds_add_u32 v18, v19
    v_cmp_gt_u32 vcc, s80, v20
    v_exp_f32 v76, v92
    v_cvt_pk_bf16_f32 v81, v78, v79
    v_exp_f32 v77, v93
    v_exp_f32 v78, v94
    v_cvt_pk_bf16_f32 v82, v76, v77
    v_exp_f32 v79, v95
    v_mfma_f32_32x32x16_bf16 v[136:151], v[68:71], v[84:87], v[136:151]
    s_cbranch_vccnz L_abar_56
L_aback_57:
    v_exp_f32 v76, v96
    v_cvt_pk_bf16_f32 v83, v78, v79
    v_exp_f32 v77, v97
    v_exp_f32 v78, v98
    v_cvt_pk_bf16_f32 v84, v76, v77
    v_exp_f32 v79, v99
    v_mfma_f32_32x32x16_bf16 v[120:135], v[56:59], v[80:83], v[120:135]
    s_waitcnt lgkmcnt(0)
    v_exp_f32 v76, v100
    v_cvt_pk_bf16_f32 v85, v78, v79
    v_exp_f32 v77, v101
    v_exp_f32 v78, v102
    v_cvt_pk_bf16_f32 v86, v76, v77
    v_exp_f32 v79, v103
    v_mfma_f32_32x32x16_bf16 v[88:103], v[52:55], v[24:27], 0
    ds_read_b128 v[48:51], v2 offset:6144
    v_exp_f32 v76, v104
    v_cvt_pk_bf16_f32 v87, v78, v79
    v_exp_f32 v77, v105
    v_exp_f32 v78, v106
    v_cvt_pk_bf16_f32 v80, v76, v77
    v_exp_f32 v79, v107
    v_mfma_f32_32x32x8_bf16 v[88:103], v[74:75], v[34:35], v[88:103]
    v_exp_f32 v76, v108
    v_cvt_pk_bf16_f32 v81, v78, v79
    v_exp_f32 v77, v109
    v_exp_f32 v78, v110
    v_cvt_pk_bf16_f32 v82, v76, v77
    v_exp_f32 v79, v111
    v_mfma_f32_32x32x16_bf16 v[120:135], v[64:67], v[84:87], v[120:135]
    ds_read_b128 v[68:71], v5 offset:6080
    v_exp_f32 v76, v112
    v_cvt_pk_bf16_f32 v83, v78, v79
    v_exp_f32 v77, v113
    v_exp_f32 v78, v114
    v_cvt_pk_bf16_f32 v84, v76, v77
    v_exp_f32 v79, v115
    v_mfma_f32_32x32x16_bf16 v[136:151], v[56:59], v[80:83], v[136:151]
    ds_read_b128 v[56:59], v4 offset:7296
    v_exp_f32 v76, v116
    v_cvt_pk_bf16_f32 v85, v78, v79
    v_exp_f32 v77, v117
    v_exp_f32 v78, v118
    v_cvt_pk_bf16_f32 v86, v76, v77
    v_exp_f32 v79, v119
    v_mfma_f32_32x32x16_bf16 v[104:119], v[52:55], v[28:31], 0
    s_mov_b32 s80, 8
    v_exp_f32 v76, v88
    v_cvt_pk_bf16_f32 v87, v78, v79
    v_exp_f32 v77, v89
    v_exp_f32 v78, v90
    v_cvt_pk_bf16_f32 v80, v76, v77
    v_exp_f32 v79, v91
    v_mfma_f32_32x32x8_bf16 v[104:119], v[74:75], v[42:43], v[104:119]
    v_exp_f32 v76, v92
    v_cvt_pk_bf16_f32 v81, v78, v79
    v_exp_f32 v77, v93
    v_exp_f32 v78, v94
    v_cvt_pk_bf16_f32 v82, v76, v77
    v_exp_f32 v79, v95
    v_mfma_f32_32x32x16_bf16 v[136:151], v[64:67], v[84:87], v[136:151]
    v_exp_f32 v76, v96
    v_cvt_pk_bf16_f32 v83, v78, v79
    v_exp_f32 v77, v97
    v_exp_f32 v78, v98
    v_cvt_pk_bf16_f32 v84, v76, v77
    v_exp_f32 v79, v99
    v_mfma_f32_32x32x16_bf16 v[120:135], v[60:63], v[80:83], v[120:135]
    s_waitcnt lgkmcnt(0)
    v_exp_f32 v76, v100
    v_cvt_pk_bf16_f32 v85, v78, v79
    v_exp_f32 v77, v101
    v_exp_f32 v78, v102
    v_cvt_pk_bf16_f32 v86, v76, v77
    v_exp_f32 v79, v103
    v_mfma_f32_32x32x16_bf16 v[88:103], v[48:51], v[24:27], 0
    ds_read_b128 v[52:55], v2 offset:7168
    v_exp_f32 v76, v104
    v_cvt_pk_bf16_f32 v87, v78, v79
    v_exp_f32 v77, v105
    v_exp_f32 v78, v106
    v_cvt_pk_bf16_f32 v80, v76, v77
    v_exp_f32 v79, v107
    v_mfma_f32_32x32x8_bf16 v[88:103], v[74:75], v[36:37], v[88:103]
    ds_read_b64 v[72:73], v3 offset:18944
    v_exp_f32 v76, v108
    v_cvt_pk_bf16_f32 v81, v78, v79
    v_exp_f32 v77, v109
    v_exp_f32 v78, v110
    v_cvt_pk_bf16_f32 v82, v76, v77
    v_exp_f32 v79, v111
    v_mfma_f32_32x32x16_bf16 v[120:135], v[68:71], v[84:87], v[120:135]
    ds_read_b128 v[64:67], v5 offset:7296
    v_exp_f32 v76, v112
    v_cvt_pk_bf16_f32 v83, v78, v79
    v_exp_f32 v77, v113
    v_exp_f32 v78, v114
    v_cvt_pk_bf16_f32 v84, v76, v77
    v_exp_f32 v79, v115
    v_mfma_f32_32x32x16_bf16 v[136:151], v[60:63], v[80:83], v[136:151]
    ds_read_b128 v[60:63], v4 offset:8512
    v_exp_f32 v76, v116
    v_cvt_pk_bf16_f32 v85, v78, v79
    v_exp_f32 v77, v117
    v_exp_f32 v78, v118
    v_cvt_pk_bf16_f32 v86, v76, v77
    v_exp_f32 v79, v119
    v_mfma_f32_32x32x16_bf16 v[104:119], v[48:51], v[28:31], 0
    v_exp_f32 v76, v88
    v_cvt_pk_bf16_f32 v87, v78, v79
    v_exp_f32 v77, v89
    v_exp_f32 v78, v90
    v_cvt_pk_bf16_f32 v80, v76, v77
    v_exp_f32 v79, v91
    v_mfma_f32_32x32x8_bf16 v[104:119], v[74:75], v[44:45], v[104:119]
    v_exp_f32 v76, v92
    v_cvt_pk_bf16_f32 v81, v78, v79
    v_exp_f32 v77, v93
    v_exp_f32 v78, v94
    v_cvt_pk_bf16_f32 v82, v76, v77
    v_exp_f32 v79, v95
    v_mfma_f32_32x32x16_bf16 v[136:151], v[68:71], v[84:87], v[136:151]
    v_exp_f32 v76, v96
    v_cvt_pk_bf16_f32 v83, v78, v79
    v_exp_f32 v77, v97
    v_exp_f32 v78, v98
    v_cvt_pk_bf16_f32 v84, v76, v77
    v_exp_f32 v79, v99
    v_mfma_f32_32x32x16_bf16 v[120:135], v[56:59], v[80:83], v[120:135]
    s_waitcnt lgkmcnt(0)
    v_exp_f32 v76, v100
    v_cvt_pk_bf16_f32 v85, v78, v79
    v_exp_f32 v77, v101
    v_exp_f32 v78, v102
    v_cvt_pk_bf16_f32 v86, v76, v77
    v_exp_f32 v79, v103
    v_mfma_f32_32x32x16_bf16 v[88:103], v[52:55], v[24:27], 0
    ds_read_b128 v[48:51], v2 offset:18944
    v_exp_f32 v76, v104
    v_cvt_pk_bf16_f32 v87, v78, v79
    v_exp_f32 v77, v105
    v_exp_f32 v78, v106
    v_cvt_pk_bf16_f32 v80, v76, v77
    v_exp_f32 v79, v107
    v_mfma_f32_32x32x8_bf16 v[88:103], v[74:75], v[38:39], v[88:103]
    v_exp_f32 v76, v108
    v_cvt_pk_bf16_f32 v81, v78, v79
    v_exp_f32 v77, v109
    v_exp_f32 v78, v110
    v_cvt_pk_bf16_f32 v82, v76, v77
    v_exp_f32 v79, v111
    v_mfma_f32_32x32x16_bf16 v[120:135], v[64:67], v[84:87], v[120:135]
    ds_read_b128 v[68:71], v5 offset:8512
    v_exp_f32 v76, v112
    v_cvt_pk_bf16_f32 v83, v78, v79
    v_exp_f32 v77, v113
    v_exp_f32 v78, v114
    v_cvt_pk_bf16_f32 v84, v76, v77
    v_exp_f32 v79, v115
    v_mfma_f32_32x32x16_bf16 v[136:151], v[56:59], v[80:83], v[136:151]
    ds_read_b128 v[56:59], v4 offset:18944
    v_exp_f32 v76, v116
    v_cvt_pk_bf16_f32 v85, v78, v79
    v_exp_f32 v77, v117
    v_exp_f32 v78, v118
    v_cvt_pk_bf16_f32 v86, v76, v77
    v_exp_f32 v79, v119
    v_mfma_f32_32x32x16_bf16 v[104:119], v[52:55], v[28:31], 0
    s_add_u32 s67, s67, 1
    v_exp_f32 v76, v88
    v_cvt_pk_bf16_f32 v87, v78, v79
    v_exp_f32 v77, v89
    v_exp_f32 v78, v90
    v_cvt_pk_bf16_f32 v80, v76, v77
    v_exp_f32 v79, v91
    v_mfma_f32_32x32x8_bf16 v[104:119], v[74:75], v[46:47], v[104:119]
    s_cmp_lt_u32 s67, 8
    v_exp_f32 v76, v92
    v_cvt_pk_bf16_f32 v81, v78, v79
    v_exp_f32 v77, v93
    v_exp_f32 v78, v94
    v_cvt_pk_bf16_f32 v82, v76, v77
    v_exp_f32 v79, v95
    v_mfma_f32_32x32x16_bf16 v[136:151], v[64:67], v[84:87], v[136:151]
    v_exp_f32 v76, v96
    v_cvt_pk_bf16_f32 v83, v78, v79
    v_exp_f32 v77, v97
    v_exp_f32 v78, v98
    v_cvt_pk_bf16_f32 v84, v76, v77
    v_exp_f32 v79, v99
    v_mfma_f32_32x32x16_bf16 v[120:135], v[60:63], v[80:83], v[120:135]
    s_waitcnt lgkmcnt(0)
    v_exp_f32 v76, v100
    v_cvt_pk_bf16_f32 v85, v78, v79
    v_exp_f32 v77, v101
    v_exp_f32 v78, v102
    v_cvt_pk_bf16_f32 v86, v76, v77
    v_exp_f32 v79, v103
    v_mfma_f32_32x32x16_bf16 v[88:103], v[48:51], v[24:27], 0
    ds_read_b128 v[52:55], v2 offset:19968
    v_exp_f32 v76, v104
    v_cvt_pk_bf16_f32 v87, v78, v79
    v_exp_f32 v77, v105
    v_exp_f32 v78, v106
    v_cvt_pk_bf16_f32 v80, v76, v77
    v_exp_f32 v79, v107
    v_mfma_f32_32x32x8_bf16 v[88:103], v[72:73], v[32:33], v[88:103]
    v_exp_f32 v76, v108
    v_cvt_pk_bf16_f32 v81, v78, v79
    v_exp_f32 v77, v109
    v_exp_f32 v78, v110
    v_cvt_pk_bf16_f32 v82, v76, v77
    v_exp_f32 v79, v111
    v_mfma_f32_32x32x16_bf16 v[120:135], v[68:71], v[84:87], v[120:135]
    ds_read_b128 v[64:67], v5 offset:18944
    v_exp_f32 v76, v112
    v_cvt_pk_bf16_f32 v83, v78, v79
    v_exp_f32 v77, v113
    v_exp_f32 v78, v114
    v_cvt_pk_bf16_f32 v84, v76, v77
    v_exp_f32 v79, v115
    v_mfma_f32_32x32x16_bf16 v[136:151], v[60:63], v[80:83], v[136:151]
    ds_read_b128 v[60:63], v4 offset:20160
    v_exp_f32 v76, v116
    v_cvt_pk_bf16_f32 v85, v78, v79
    v_exp_f32 v77, v117
    v_exp_f32 v78, v118
    v_cvt_pk_bf16_f32 v86, v76, v77
    v_exp_f32 v79, v119
    v_add_u32 v2, 18944, v2
    v_add_u32 v3, 18944, v3
    v_add_u32 v4, 18944, v4
    v_add_u32 v5, 18944, v5
    s_cbranch_scc1 L_aloop_59
L_aepi_58:
    v_cvt_pk_bf16_f32 v87, v78, v79
    v_mov_b32 v6, v130
    v_mov_b32 v10, v130
    v_mfma_f32_32x32x16_bf16 v[136:151], v[68:71], v[84:87], v[136:151]
    s_mov_b64 s[78:79], 0
    v_permlane32_swap_b32 v6, v10
    v_rcp_f32 v8, v6
    s_nop 0
    v_mul_f32 v94, v8, v120
    v_mul_f32 v95, v8, v121
    v_mul_f32 v96, v8, v122
    v_mul_f32 v97, v8, v123
    v_mul_f32 v98, v8, v124
    v_mul_f32 v99, v8, v125
    v_mul_f32 v100, v8, v126
    v_mul_f32 v101, v8, v127
    v_mul_f32 v102, v8, v128
    v_mul_f32 v103, v8, v129
    v_cvt_pk_bf16_f32 v92, v102, v103
    v_cvt_pk_bf16_f32 v88, v94, v95
    v_cvt_pk_bf16_f32 v89, v96, v97
    v_cvt_pk_bf16_f32 v90, v98, v99
    v_cvt_pk_bf16_f32 v91, v100, v101
    buffer_store_dwordx4 v[88:91], v13, s[16:19], s82 offen sc1
    v_mov_b32 v7, v146
    v_mov_b32 v10, v146
    s_nop 0
    s_mov_b64 s[78:79], 0
    v_permlane32_swap_b32 v7, v10
    v_rcp_f32 v9, v7
    s_nop 0
    v_mul_f32 v110, v9, v136
    v_mul_f32 v111, v9, v137
    v_mul_f32 v112, v9, v138
    v_mul_f32 v113, v9, v139
    v_mul_f32 v114, v9, v140
    v_mul_f32 v115, v9, v141
    v_mul_f32 v116, v9, v142
    v_mul_f32 v117, v9, v143
    v_mul_f32 v118, v9, v144
    v_mul_f32 v119, v9, v145
    v_cvt_pk_bf16_f32 v108, v118, v119
    v_cvt_pk_bf16_f32 v104, v110, v111
    v_cvt_pk_bf16_f32 v105, v112, v113
    v_cvt_pk_bf16_f32 v106, v114, v115
    v_cvt_pk_bf16_f32 v107, v116, v117
    buffer_store_dwordx4 v[104:107], v13, s[16:19], s83 offen sc1
    v_permlane32_swap_b32 v92, v108
    buffer_store_dword v92, v14, s[16:19], s81 offen sc1
    v_max3_f32 v8, abs(v120), abs(v121), abs(v122)
    v_max3_f32 v9, abs(v123), abs(v124), abs(v125)
    v_max3_f32 v8, v8, abs(v126), abs(v127)
    v_max3_f32 v9, v9, abs(v128), abs(v129)
    v_max_f32 v8, v8, v9
    v_cmp_nle_f32 s[70:71], s69, v6
    v_cmp_nge_f32 s[72:73], s76, v6
    v_cmp_nge_f32 vcc, s77, v8
    s_or_b64 s[78:79], s[78:79], s[70:71]
    s_or_b64 s[78:79], s[78:79], s[72:73]
    s_or_b64 s[78:79], s[78:79], vcc
    v_max3_f32 v8, abs(v136), abs(v137), abs(v138)
    v_max3_f32 v9, abs(v139), abs(v140), abs(v141)
    v_max3_f32 v8, v8, abs(v142), abs(v143)
    v_max3_f32 v9, v9, abs(v144), abs(v145)
    v_max_f32 v8, v8, v9
    v_cmp_nle_f32 s[70:71], s69, v7
    v_cmp_nge_f32 s[72:73], s76, v7
    v_cmp_nge_f32 vcc, s77, v8
    s_or_b64 s[78:79], s[78:79], s[70:71]
    s_or_b64 s[78:79], s[78:79], s[72:73]
    s_or_b64 s[78:79], s[78:79], vcc
    s_cmp_eq_u64 s[78:79], 0
    s_cbranch_scc1 L_adone_53
    v_mov_b32 v8, 163836
    v_mov_b32 v9, 1
    ds_write_b32 v8, v9
L_adone_53:
    v_mov_b32 v8, 163836
    s_waitcnt vmcnt(0) lgkmcnt(0)
    s_barrier
    s_cmp_lg_u32 s68, 0
    s_cbranch_scc1 L_aout2_55
    ds_read_b32 v9, v8
    s_waitcnt lgkmcnt(0)
    v_readfirstlane_b32 s64, v9
    s_cmp_lg_u32 s64, 0
    s_cbranch_scc1 L_aredo_52
L_aout_54:
    s_cmp_ge_u32 s61, 24
    s_cbranch_scc1 L_end
    s_mov_b32 s100, 2
    s_branch L_pre_45
L_help_43:
    v_lshlrev_b32 v225, 4, v1
    s_and_b32 s64, s61, 7
    s_mul_i32 s64, s64, 72
    v_min_u32 v4, 35, v1
    v_lshl_add_u32 v4, v4, 1, s64
    v_subrev_u32 v5, 384, v4
    v_mul_u32_u24 v5, 171, v5
    v_lshrrev_b32 v5, 9, v5
    v_add_u32 v5, 192, v5
    s_movk_i32 s64, 384
    v_cmp_gt_u32 s[64:65], s64, v4
    v_lshrrev_b32 v4, 1, v4
    s_nop 0
    v_cndmask_b32 v4, v5, v4, s[64:65]
    v_lshlrev_b32 v246, 7, v4
    v_and_b32 v224, 31, v1
    v_lshlrev_b32 v224, 7, v224
    v_mov_b32 v248, 163836
    v_mov_b32 v5, 0
    v_mov_b32 v249, 163828
    ds_write_b32 v249, v5
    ds_write_b32 v249, v5 offset:4
    ds_write_b32 v249, v5 offset:8
    v_mov_b32 v255, 1
    v_mov_b32 v16, 2147483632
    v_mov_b32 v17, 2147483632
    v_lshrrev_b32 v226, 3, v1
    v_and_b32 v227, 7, v1
    v_bfe_u32 v228, v1, 4, 1
    v_lshlrev_b32 v228, 2, v228
    v_xor_b32 v227, v227, v228
    v_lshlrev_b32 v226, 12, v226
    v_lshl_add_u32 v226, v227, 4, v226
    s_and_b32 s79, s3, 3
    s_and_b32 s71, s61, 7
    s_mul_i32 s71, s71, 9
    s_add_u32 s71, s71, s79
    s_lshl_b32 s72, s60, 2
    s_lshr_b32 s73, s61, 3
    s_add_u32 s72, s72, s73
    s_lshl_b32 s76, s71, 15
    s_lshl_b32 s77, s72, 7
    s_add_u32 s76, s76, s77
    s_add_u32 s76, s76, 11927552
    s_mul_i32 s77, s79, 3072
    s_add_u32 s77, s77, 151552
    v_bfe_u32 v227, v1, 2, 2
    v_lshrrev_b32 v228, 4, v1
    v_bfe_u32 v229, v1, 3, 1
    v_lshlrev_b32 v229, 1, v229
    v_xor_b32 v229, v229, v228
    v_lshlrev_b32 v227, 7, v227
    v_lshl_add_u32 v227, v229, 5, v227
    v_and_b32 v229, 3, v1
    v_lshl_add_u32 v227, v229, 3, v227
    v_add_u32 v227, s77, v227
    v_and_b32 v229, 1, v1
    v_bfe_u32 v228, v1, 1, 3
    v_lshl_add_u32 v229, v228, 2, v229
    v_bfe_u32 v228, v1, 4, 1
    v_lshl_add_u32 v229, v228, 1, v229
    v_and_b32 v228, 32, v1
    v_add_u32 v229, v229, v228
    v_mul_u32_u24 v229, 2304, v229
    s_mul_i32 s78, s72, 147456
    s_lshl_b32 s71, s71, 4
    s_add_u32 s78, s78, s71
    v_add_u32 v2, 0, v1
    v_mul_u32_u24 v3, 171, v2
    v_lshrrev_b32 v3, 11, v3
    v_mul_u32_u24 v4, 12, v3
    v_sub_u32 v2, v2, v4
    v_lshrrev_b32 v4, 3, v3
    v_lshlrev_b32 v5, 1, v4
    v_xor_b32 v2, v2, v5
    v_lshlrev_b32 v2, 4, v2
    v_and_b32 v5, 3, v3
    v_bfe_u32 v6, v3, 2, 1
    v_lshl_add_u32 v5, v6, 3, v5
    v_lshl_add_u32 v5, v4, 2, v5
    v_mul_u32_u24 v5, 1152, v5
    v_add_u32 v8, v5, v2
    v_lshrrev_b32 v5, 1, v3
    v_mul_u32_u24 v5, 18, v5
    v_and_b32 v6, 1, v3
    v_add3_u32 v5, v5, v6, 16
    v_bfe_u32 v6, v3, 1, 1
    v_lshlrev_b32 v6, 4, v6
    v_sub_u32 v5, v5, v6
    v_mul_u32_u24 v5, 1152, v5
    v_add_u32 v11, v5, v2
    v_add_u32 v2, 64, v1
    v_mul_u32_u24 v3, 171, v2
    v_lshrrev_b32 v3, 11, v3
    v_mul_u32_u24 v4, 12, v3
    v_sub_u32 v2, v2, v4
    v_lshrrev_b32 v4, 3, v3
    v_lshlrev_b32 v5, 1, v4
    v_xor_b32 v2, v2, v5
    v_lshlrev_b32 v2, 4, v2
    v_and_b32 v5, 3, v3
    v_bfe_u32 v6, v3, 2, 1
    v_lshl_add_u32 v5, v6, 3, v5
    v_lshl_add_u32 v5, v4, 2, v5
    v_mul_u32_u24 v5, 1152, v5
    v_add_u32 v9, v5, v2
    v_lshrrev_b32 v5, 1, v3
    v_mul_u32_u24 v5, 18, v5
    v_and_b32 v6, 1, v3
    v_add3_u32 v5, v5, v6, 16
    v_bfe_u32 v6, v3, 1, 1
    v_lshlrev_b32 v6, 4, v6
    v_sub_u32 v5, v5, v6
    v_mul_u32_u24 v5, 1152, v5
    v_add_u32 v12, v5, v2
    v_add_u32 v2, 128, v1
    v_mul_u32_u24 v3, 171, v2
    v_lshrrev_b32 v3, 11, v3
    v_mul_u32_u24 v4, 12, v3
    v_sub_u32 v2, v2, v4
    v_lshrrev_b32 v4, 3, v3
    v_lshlrev_b32 v5, 1, v4
    v_xor_b32 v2, v2, v5
    v_lshlrev_b32 v2, 4, v2
    v_and_b32 v5, 3, v3
    v_bfe_u32 v6, v3, 2, 1
    v_lshl_add_u32 v5, v6, 3, v5
    v_lshl_add_u32 v5, v4, 2, v5
    v_mul_u32_u24 v5, 1152, v5
    v_add_u32 v10, v5, v2
    v_lshrrev_b32 v5, 1, v3
    v_mul_u32_u24 v5, 18, v5
    v_and_b32 v6, 1, v3
    v_add3_u32 v5, v5, v6, 16
    v_bfe_u32 v6, v3, 1, 1
    v_lshlrev_b32 v6, 4, v6
    v_sub_u32 v5, v5, v6
    v_mul_u32_u24 v5, 1152, v5
    v_add_u32 v13, v5, v2
    s_cmp_lt_u32 s3, 6
    s_cbranch_scc1 L_nopoll_60
    v_and_b32 v4, 15, v1
    v_lshrrev_b32 v5, 4, v1
    v_min_u32 v5, 2, v5
    v_and_b32 v6, 1, v1
    s_lshl_b32 s64, s63, 1
    v_add_u32 v6, s64, v6
    v_cmp_eq_u32 s[64:65], 0, v5
    v_lshlrev_b32 v5, 6, v5
    s_lshr_b32 s66, s62, 3
    v_cndmask_b32 v6, v4, v6, s[64:65]
    v_add_u32 v6, v6, v5
    v_lshlrev_b32 v247, 7, v6
    s_lshl_b32 s88, s66, 11
    s_add_u32 s88, s88, 14548992
    s_mov_b32 s87, 0
L_spin_61:
    buffer_load_dwordx2 v[244:245], v247, s[16:19], s88 offen sc1
    s_waitcnt vmcnt(0)
    v_cmp_ne_u64 vcc, v[250:251], v[244:245]
    s_add_u32 s87, s87, 1
    s_cbranch_vccz L_spun_62
    s_sleep 2
    s_cmp_lt_u32 s87, 65536
    s_cbranch_scc1 L_spin_61
L_spun_62:
    s_and_b32 s64, s3, 1
    s_lshl_b32 s65, s62, 16
    s_lshl_b32 s66, s63, 13
    s_add_u32 s65, s65, s66
    s_lshl_b32 s66, s64, 12
    s_add_u32 s65, s65, s66
    s_add_u32 m0, s66, 153728
    s_add_u32 s65, s65, 4849664
    s_mul_i32 s67, s62, 151552
    s_add_u32 s67, s67, s66
    s_add_u32 s67, s67, 0
    buffer_load_dwordx4 v225, s[16:19], s65 offen sc1 lds
    buffer_load_dwordx4 v225, s[16:19], s65 offen offset:1024 sc1 lds
    buffer_load_dwordx4 v225, s[16:19], s65 offen offset:2048 sc1 lds
    buffer_load_dwordx4 v225, s[16:19], s65 offen offset:3072 sc1 lds
    s_lshl_b32 s65, s62, 13
    s_lshl_b32 s68, s63, 10
    s_add_u32 s65, s65, s68
    s_mov_b32 m0, 161920
    s_add_u32 s65, s65, 6946816
    buffer_load_dwordx4 v225, s[16:19], s65 offen sc1 lds
    s_add_u32 m0, s66, 0
    s_nop 0
    buffer_load_dwordx4 v225, s[16:19], s67 offen sc1 lds
    buffer_load_dwordx4 v225, s[16:19], s67 offen offset:1024 sc1 lds
    buffer_load_dwordx4 v225, s[16:19], s67 offen offset:2048 sc1 lds
    buffer_load_dwordx4 v225, s[16:19], s67 offen offset:3072 sc1 lds
    s_add_u32 m0, s66, 8192
    s_add_u32 s67, s67, 8192
    buffer_load_dwordx4 v225, s[16:19], s67 offen sc1 lds
    buffer_load_dwordx4 v225, s[16:19], s67 offen offset:1024 sc1 lds
    buffer_load_dwordx4 v225, s[16:19], s67 offen offset:2048 sc1 lds
    buffer_load_dwordx4 v225, s[16:19], s67 offen offset:3072 sc1 lds
    s_add_u32 m0, s66, 16384
    s_add_u32 s67, s67, 8192
    buffer_load_dwordx4 v225, s[16:19], s67 offen sc1 lds
    buffer_load_dwordx4 v225, s[16:19], s67 offen offset:1024 sc1 lds
    buffer_load_dwordx4 v225, s[16:19], s67 offen offset:2048 sc1 lds
    buffer_load_dwordx4 v225, s[16:19], s67 offen offset:3072 sc1 lds
L_nopoll_60:
    v_mov_b32 v247, v246
    s_mov_b32 s88, 14581760
    s_waitcnt vmcnt(0) lgkmcnt(0)
    s_barrier
    s_and_b32 s66, s3, 3
    s_lshl_b32 s66, s66, 12
    s_add_u32 s66, s66, 24576
    s_mul_i32 s67, s62, 151552
    s_add_u32 s67, s67, s66
    s_add_u32 s67, s67, 0
    s_add_u32 m0, s66, 0
    s_nop 0
    buffer_load_dwordx4 v225, s[16:19], s67 offen sc1 lds
    buffer_load_dwordx4 v225, s[16:19], s67 offen offset:1024 sc1 lds
    buffer_load_dwordx4 v225, s[16:19], s67 offen offset:2048 sc1 lds
    buffer_load_dwordx4 v225, s[16:19], s67 offen offset:3072 sc1 lds
    s_add_u32 m0, s66, 16384
    s_add_u32 s67, s67, 16384
    buffer_load_dwordx4 v225, s[16:19], s67 offen sc1 lds
    buffer_load_dwordx4 v225, s[16:19], s67 offen offset:1024 sc1 lds
    buffer_load_dwordx4 v225, s[16:19], s67 offen offset:2048 sc1 lds
    buffer_load_dwordx4 v225, s[16:19], s67 offen offset:3072 sc1 lds
    s_add_u32 m0, s66, 32768
    s_add_u32 s67, s67, 16384
    buffer_load_dwordx4 v225, s[16:19], s67 offen sc1 lds
    buffer_load_dwordx4 v225, s[16:19], s67 offen offset:1024 sc1 lds
    buffer_load_dwordx4 v225, s[16:19], s67 offen offset:2048 sc1 lds
    buffer_load_dwordx4 v225, s[16:19], s67 offen offset:3072 sc1 lds
    s_waitcnt vmcnt(8)
    s_mov_b64 exec, 1
    ds_add_u32 v249, v255 offset:4
    s_mov_b64 exec, -1
    s_add_u32 m0, s66, 49152
    s_add_u32 s67, s67, 16384
    buffer_load_dwordx4 v225, s[16:19], s67 offen sc1 lds
    buffer_load_dwordx4 v225, s[16:19], s67 offen offset:1024 sc1 lds
    buffer_load_dwordx4 v225, s[16:19], s67 offen offset:2048 sc1 lds
    buffer_load_dwordx4 v225, s[16:19], s67 offen offset:3072 sc1 lds
    s_add_u32 m0, s66, 65536
    s_add_u32 s67, s67, 16384
    buffer_load_dwordx4 v225, s[16:19], s67 offen sc1 lds
    buffer_load_dwordx4 v225, s[16:19], s67 offen offset:1024 sc1 lds
    buffer_load_dwordx4 v225, s[16:19], s67 offen offset:2048 sc1 lds
    buffer_load_dwordx4 v225, s[16:19], s67 offen offset:3072 sc1 lds
    s_add_u32 m0, s66, 81920
    s_add_u32 s67, s67, 16384
    buffer_load_dwordx4 v225, s[16:19], s67 offen sc1 lds
    buffer_load_dwordx4 v225, s[16:19], s67 offen offset:1024 sc1 lds
    buffer_load_dwordx4 v225, s[16:19], s67 offen offset:2048 sc1 lds
    buffer_load_dwordx4 v225, s[16:19], s67 offen offset:3072 sc1 lds
    s_add_u32 m0, s66, 98304
    s_add_u32 s67, s67, 16384
    buffer_load_dwordx4 v225, s[16:19], s67 offen sc1 lds
    buffer_load_dwordx4 v225, s[16:19], s67 offen offset:1024 sc1 lds
    buffer_load_dwordx4 v225, s[16:19], s67 offen offset:2048 sc1 lds
    buffer_load_dwordx4 v225, s[16:19], s67 offen offset:3072 sc1 lds
    s_cmp_ge_u32 s3, 7
    s_cbranch_scc1 L_kvlast_63
    s_add_u32 m0, s66, 114688
    s_add_u32 s67, s67, 16384
    buffer_load_dwordx4 v225, s[16:19], s67 offen sc1 lds
    buffer_load_dwordx4 v225, s[16:19], s67 offen offset:1024 sc1 lds
    buffer_load_dwordx4 v225, s[16:19], s67 offen offset:2048 sc1 lds
    buffer_load_dwordx4 v225, s[16:19], s67 offen offset:3072 sc1 lds
L_kvlast_63:
L_lw_64:
    ds_read_b32 v243, v249 offset:4
    s_waitcnt lgkmcnt(0)
    v_readfirstlane_b32 s89, v243
    s_add_u32 s89, s89, 124
    s_and_b32 s89, s89, 128
    s_cmp_eq_u32 s89, 128
    s_cbranch_scc1 L_lwd_65
    s_sleep 1
    s_branch L_lw_64
L_lwd_65:
    s_waitcnt vmcnt(0)
    s_mov_b64 exec, 1
    ds_add_u32 v249, v255 offset:4
    s_mov_b64 exec, -1
L_lw_66:
    ds_read_b32 v243, v249 offset:0
    s_waitcnt lgkmcnt(0)
    v_readfirstlane_b32 s89, v243
    s_add_u32 s89, s89, 2139062143
    s_and_b32 s89, s89, 2155905152
    s_cmp_eq_u32 s89, 2155905152
    s_cbranch_scc1 L_lwd_67
    s_sleep 8
    s_branch L_lw_66
L_lwd_67:
L_lw_68:
    ds_read_b32 v243, v249 offset:4
    s_waitcnt lgkmcnt(0)
    v_readfirstlane_b32 s89, v243
    s_add_u32 s89, s89, 120
    s_and_b32 s89, s89, 128
    s_cmp_eq_u32 s89, 128
    s_cbranch_scc1 L_lwd_69
    s_sleep 2
    s_branch L_lw_68
L_lwd_69:
    s_cmp_lg_u32 s3, 4
    s_cbranch_scc1 L_fset_70
    v_mov_b32 v242, 0
    s_mov_b64 exec, 1
    buffer_store_dwordx2 v[250:251], v242, s[16:19], s85 offen sc1
    s_mov_b64 exec, -1
L_fset_70:
L_lw_71:
    ds_read_b32 v243, v249 offset:0
    s_waitcnt lgkmcnt(0)
    v_readfirstlane_b32 s89, v243
    s_add_u32 s89, s89, 2122219134
    s_and_b32 s89, s89, 2155905152
    s_cmp_eq_u32 s89, 2155905152
    s_cbranch_scc1 L_lwd_72
    s_sleep 8
    s_branch L_lw_71
L_lwd_72:
    s_mov_b32 s87, 0
L_spin_73:
    buffer_load_dwordx2 v[244:245], v247, s[16:19], s88 offen sc1
    s_waitcnt vmcnt(0)
    v_cmp_ne_u64 vcc, v[250:251], v[244:245]
    s_add_u32 s87, s87, 1
    s_cbranch_vccz L_spun_74
    s_sleep 2
    s_cmp_lt_u32 s87, 65536
    s_cbranch_scc1 L_spin_73
L_spun_74:
    s_mov_b32 m0, s77
    s_nop 0
    buffer_load_dwordx4 v226, s[16:19], s76 offen sc1 lds
    s_add_u32 m0, s77, 1024
    s_add_u32 s76, s76, 131072
    buffer_load_dwordx4 v226, s[16:19], s76 offen sc1 lds
    s_add_u32 m0, s77, 2048
    s_add_u32 s76, s76, 131072
    s_cmp_lg_u32 s79, 0
    s_cbranch_scc1 L_ytskip_75
    buffer_load_dwordx4 v226, s[16:19], s76 offen sc1 lds
L_ytskip_75:
    s_waitcnt vmcnt(0)
    ds_read_b64_tr_b16 v[230:231], v227 offset:0
    ds_read_b64_tr_b16 v[232:233], v227 offset:512
    s_waitcnt lgkmcnt(0)
    buffer_store_dwordx4 v[230:233], v229, s[20:23], s78 offen offset:0 sc1
    ds_read_b64_tr_b16 v[234:235], v227 offset:1024
    ds_read_b64_tr_b16 v[236:237], v227 offset:1536
    s_waitcnt lgkmcnt(0)
    buffer_store_dwordx4 v[234:237], v229, s[20:23], s78 offen offset:64 sc1
    s_cmp_lg_u32 s79, 0
    s_cbranch_scc1 L_ytend_76
    ds_read_b64_tr_b16 v[238:239], v227 offset:2048
    ds_read_b64_tr_b16 v[240:241], v227 offset:2560
    s_waitcnt lgkmcnt(0)
    buffer_store_dwordx4 v[238:241], v229, s[20:23], s78 offen offset:128 sc1
L_ytend_76:
    v_mov_b32 v247, v224
    s_lshr_b32 s88, s90, 2
    s_lshl_b32 s88, s88, 12
    s_add_u32 s88, s88, 14614528
    s_cmp_ge_u32 s61, 24
    s_cbranch_scc1 L_nowo3_78
L_lw_81:
    ds_read_b32 v243, v249 offset:0
    s_waitcnt lgkmcnt(0)
    v_readfirstlane_b32 s89, v243
    s_add_u32 s89, s89, 2038004089
    s_and_b32 s89, s89, 2155905152
    s_cmp_eq_u32 s89, 2155905152
    s_cbranch_scc1 L_lwd_82
    s_sleep 16
    s_branch L_lw_81
L_lwd_82:
    s_and_b32 s67, s3, 3
    s_mul_i32 s64, s91, 192
    s_mul_i32 s65, s67, 20736
    s_add_u32 s65, s65, s64
    s_and_b32 s66, s67, 1
    s_mul_i32 s66, s66, 2304
    s_add_u32 s65, s65, s66
    s_mul_i32 s66, s67, 3072
    s_add_u32 m0, s66, 0
    s_nop 0
    buffer_load_dwordx4 v8, s[28:31], s65 offen lds
    s_add_u32 m0, s66, 1024
    s_nop 0
    buffer_load_dwordx4 v9, s[28:31], s65 offen lds
    s_add_u32 m0, s66, 2048
    s_nop 0
    buffer_load_dwordx4 v10, s[28:31], s65 offen lds
    s_add_u32 m0, s66, 12288
    s_add_u32 s65, s65, 82944
    buffer_load_dwordx4 v8, s[28:31], s65 offen lds
    s_add_u32 m0, s66, 13312
    s_nop 0
    buffer_load_dwordx4 v9, s[28:31], s65 offen lds
    s_add_u32 m0, s66, 14336
    s_nop 0
    buffer_load_dwordx4 v10, s[28:31], s65 offen lds
    s_add_u32 m0, s66, 24576
    s_add_u32 s65, s65, 82944
    buffer_load_dwordx4 v8, s[28:31], s65 offen lds
    s_add_u32 m0, s66, 25600
    s_nop 0
    buffer_load_dwordx4 v9, s[28:31], s65 offen lds
    s_add_u32 m0, s66, 26624
    s_nop 0
    buffer_load_dwordx4 v10, s[28:31], s65 offen lds
    s_add_u32 m0, s66, 36864
    s_add_u32 s65, s65, 82944
    buffer_load_dwordx4 v8, s[28:31], s65 offen lds
    s_add_u32 m0, s66, 37888
    s_nop 0
    buffer_load_dwordx4 v9, s[28:31], s65 offen lds
    s_add_u32 m0, s66, 38912
    s_nop 0
    buffer_load_dwordx4 v10, s[28:31], s65 offen lds
    s_add_u32 m0, s66, 49152
    s_add_u32 s65, s65, 82944
    buffer_load_dwordx4 v8, s[28:31], s65 offen lds
    s_add_u32 m0, s66, 50176
    s_nop 0
    buffer_load_dwordx4 v9, s[28:31], s65 offen lds
    s_add_u32 m0, s66, 51200
    s_nop 0
    buffer_load_dwordx4 v10, s[28:31], s65 offen lds
    s_add_u32 m0, s66, 61440
    s_add_u32 s65, s65, 82944
    buffer_load_dwordx4 v8, s[28:31], s65 offen lds
    s_add_u32 m0, s66, 62464
    s_nop 0
    buffer_load_dwordx4 v9, s[28:31], s65 offen lds
    s_add_u32 m0, s66, 63488
    s_nop 0
    buffer_load_dwordx4 v10, s[28:31], s65 offen lds
    s_add_u32 m0, s66, 73728
    s_add_u32 s65, s65, 82944
    buffer_load_dwordx4 v8, s[28:31], s65 offen lds
    s_add_u32 m0, s66, 74752
    s_nop 0
    buffer_load_dwordx4 v9, s[28:31], s65 offen lds
    s_add_u32 m0, s66, 75776
    s_nop 0
    buffer_load_dwordx4 v10, s[28:31], s65 offen lds
    s_add_u32 m0, s66, 86016
    s_add_u32 s65, s65, 82944
    buffer_load_dwordx4 v8, s[28:31], s65 offen lds
    s_add_u32 m0, s66, 87040
    s_nop 0
    buffer_load_dwordx4 v9, s[28:31], s65 offen lds
    s_add_u32 m0, s66, 88064
    s_nop 0
    buffer_load_dwordx4 v10, s[28:31], s65 offen lds
    s_mul_i32 s65, s67, 165888
    s_add_u32 s65, s65, s64
    s_add_u32 m0, s66, 98304
    s_nop 0
    buffer_load_dwordx4 v11, s[28:31], s65 offen lds
    s_add_u32 m0, s66, 99328
    s_nop 0
    buffer_load_dwordx4 v12, s[28:31], s65 offen lds
    s_add_u32 m0, s66, 100352
    s_nop 0
    buffer_load_dwordx4 v13, s[28:31], s65 offen lds
    s_waitcnt vmcnt(0)
L_nowo3_78:
    s_barrier
    ds_read_b32 v243, v248
    s_waitcnt lgkmcnt(0)
    v_readfirstlane_b32 s89, v243
    s_cmp_lg_u32 s89, 0
    s_cbranch_scc1 L_hredo_79
L_hz_80:
    s_cmp_lg_u32 s3, 4
    s_cbranch_scc1 L_fset_83
    v_mov_b32 v242, 0
    s_mov_b64 exec, 1
    buffer_store_dwordx2 v[250:251], v242, s[16:19], s86 offen sc1
    s_mov_b64 exec, -1
L_fset_83:
    s_cmp_ge_u32 s61, 24
    s_cbranch_scc1 L_end
L_pre_45:
    s_lshl_b32 s64, s90, 2
    s_and_b32 s65, s3, 3
    s_add_u32 s64, s64, s65
    s_mul_i32 s64, s64, 18432
    s_lshl_b32 s68, s90, 13
    s_lshl_b32 s65, s65, 6
    s_add_u32 s68, s68, s65
    s_add_u32 s68, s68, 14286848
    s_add_u32 s69, s68, 4096
    s_lshr_b32 s65, s3, 2
    s_mul_i32 s65, s65, 9216
    s_add_u32 s64, s64, s65
    s_add_u32 s64, s64, 7208960
    s_add_u32 s65, s64, 4096
    s_add_u32 s66, s64, 8192
    v_lshlrev_b32 v7, 4, v1
    v_lshrrev_b32 v6, 4, v1
    v_and_b32 v5, 15, v1
    v_lshlrev_b32 v6, 10, v6
    v_lshl_add_u32 v6, v5, 2, v6
    v_lshrrev_b32 v2, 4, v1
    v_bfe_u32 v3, v1, 2, 2
    v_lshl_add_u32 v3, v2, 3, v3
    v_mul_u32_u24 v3, 192, v3
    v_and_b32 v4, 3, v1
    v_lshl_add_u32 v3, v4, 3, v3
    s_lshr_b32 s67, s3, 2
    s_mul_i32 s70, s67, -43008
    s_add_u32 s70, s70, 98304
    s_mul_i32 s67, s67, 55296
    v_add_u32 v3, s67, v3
    v_and_b32 v4, 1, v2
    v_lshlrev_b32 v4, 5, v4
    v_add_u32 v14, v3, v4
    v_sub_u32 v15, v3, v4
    v_add_u32 v18, s70, v14
    v_add_u32 v19, s70, v15
    ds_read_b64_tr_b16 v[56:57], v14 offset:0
    ds_read_b64_tr_b16 v[58:59], v14 offset:768
    ds_read_b64_tr_b16 v[60:61], v15 offset:32
    ds_read_b64_tr_b16 v[62:63], v15 offset:800
    ds_read_b64_tr_b16 v[64:65], v14 offset:64
    ds_read_b64_tr_b16 v[66:67], v14 offset:832
    ds_read_b64_tr_b16 v[68:69], v15 offset:96
    ds_read_b64_tr_b16 v[70:71], v15 offset:864
    ds_read_b64_tr_b16 v[72:73], v14 offset:128
    ds_read_b64_tr_b16 v[74:75], v14 offset:896
    ds_read_b64_tr_b16 v[76:77], v15 offset:160
    ds_read_b64_tr_b16 v[78:79], v15 offset:928
    ds_read_b64_tr_b16 v[80:81], v14 offset:6144
    ds_read_b64_tr_b16 v[82:83], v14 offset:6912
    ds_read_b64_tr_b16 v[84:85], v15 offset:6176
    ds_read_b64_tr_b16 v[86:87], v15 offset:6944
    ds_read_b64_tr_b16 v[88:89], v14 offset:6208
    ds_read_b64_tr_b16 v[90:91], v14 offset:6976
    ds_read_b64_tr_b16 v[92:93], v15 offset:6240
    ds_read_b64_tr_b16 v[94:95], v15 offset:7008
    ds_read_b64_tr_b16 v[96:97], v14 offset:6272
    ds_read_b64_tr_b16 v[98:99], v14 offset:7040
    ds_read_b64_tr_b16 v[100:101], v15 offset:6304
    ds_read_b64_tr_b16 v[102:103], v15 offset:7072
    ds_read_b64_tr_b16 v[104:105], v14 offset:12288
    ds_read_b64_tr_b16 v[106:107], v14 offset:13056
    ds_read_b64_tr_b16 v[108:109], v15 offset:12320
    ds_read_b64_tr_b16 v[110:111], v15 offset:13088
    ds_read_b64_tr_b16 v[112:113], v14 offset:12352
    ds_read_b64_tr_b16 v[114:115], v14 offset:13120
    ds_read_b64_tr_b16 v[116:117], v15 offset:12384
    ds_read_b64_tr_b16 v[118:119], v15 offset:13152
    ds_read_b64_tr_b16 v[120:121], v14 offset:12416
    ds_read_b64_tr_b16 v[122:123], v14 offset:13184
    ds_read_b64_tr_b16 v[124:125], v15 offset:12448
    ds_read_b64_tr_b16 v[126:127], v15 offset:13216
    ds_read_b64_tr_b16 v[128:129], v14 offset:18432
    ds_read_b64_tr_b16 v[130:131], v14 offset:19200
    ds_read_b64_tr_b16 v[132:133], v15 offset:18464
    ds_read_b64_tr_b16 v[134:135], v15 offset:19232
    ds_read_b64_tr_b16 v[136:137], v14 offset:18496
    ds_read_b64_tr_b16 v[138:139], v14 offset:19264
    ds_read_b64_tr_b16 v[140:141], v15 offset:18528
    ds_read_b64_tr_b16 v[142:143], v15 offset:19296
    ds_read_b64_tr_b16 v[144:145], v14 offset:18560
    ds_read_b64_tr_b16 v[146:147], v14 offset:19328
    ds_read_b64_tr_b16 v[148:149], v15 offset:18592
    ds_read_b64_tr_b16 v[150:151], v15 offset:19360
    ds_read_b64_tr_b16 v[152:153], v14 offset:24576
    ds_read_b64_tr_b16 v[154:155], v14 offset:25344
    ds_read_b64_tr_b16 v[156:157], v15 offset:24608
    ds_read_b64_tr_b16 v[158:159], v15 offset:25376
    ds_read_b64_tr_b16 v[160:161], v14 offset:24640
    ds_read_b64_tr_b16 v[162:163], v14 offset:25408
    ds_read_b64_tr_b16 v[164:165], v15 offset:24672
    ds_read_b64_tr_b16 v[166:167], v15 offset:25440
    ds_read_b64_tr_b16 v[168:169], v14 offset:24704
    ds_read_b64_tr_b16 v[170:171], v14 offset:25472
    ds_read_b64_tr_b16 v[172:173], v15 offset:24736
    ds_read_b64_tr_b16 v[174:175], v15 offset:25504
    ds_read_b64_tr_b16 v[176:177], v14 offset:30720
    ds_read_b64_tr_b16 v[178:179], v14 offset:31488
    ds_read_b64_tr_b16 v[180:181], v15 offset:30752
    ds_read_b64_tr_b16 v[182:183], v15 offset:31520
    ds_read_b64_tr_b16 v[184:185], v14 offset:30784
    ds_read_b64_tr_b16 v[186:187], v14 offset:31552
    ds_read_b64_tr_b16 v[188:189], v15 offset:30816
    ds_read_b64_tr_b16 v[190:191], v15 offset:31584
    ds_read_b64_tr_b16 v[192:193], v14 offset:30848
    ds_read_b64_tr_b16 v[194:195], v14 offset:31616
    ds_read_b64_tr_b16 v[196:197], v15 offset:30880
    ds_read_b64_tr_b16 v[198:199], v15 offset:31648
    s_mul_i32 s70, s3, 3072
    s_xor_b32 s71, s3, 4
    s_mul_i32 s71, s71, 3072
    v_lshlrev_b32 v3, 4, v1
    v_add_u32 v3, 110592, v3
    v_add_u32 v8, s70, v3
    v_add_u32 v9, s71, v3
    s_mul_i32 s70, s3, 2048
    s_add_u32 s70, s70, 135168
    v_and_b32 v4, 15, v1
    v_mul_u32_u24 v4, 112, v4
    v_lshl_add_u32 v4, v2, 3, v4
    v_add_u32 v10, s70, v4
    s_lshl_b32 s72, s90, 2
    s_and_b32 s71, s3, 3
    s_add_u32 s72, s72, s71
    s_mul_i32 s72, s72, 36864
    s_mul_i32 s71, s91, 192
    s_add_u32 s72, s72, s71
    s_lshr_b32 s71, s3, 2
    s_mul_i32 s71, s71, 96
    s_add_u32 s72, s72, s71
    s_add_u32 s72, s72, 1152
    v_add_u32 v2, 0, v1
    v_mul_u32_u24 v3, 171, v2
    v_lshrrev_b32 v3, 10, v3
    v_lshlrev_b32 v2, 4, v2
    v_lshl_add_u32 v4, v3, 4, v2
    v_add_u32 v11, s70, v4
    v_mul_u32_u24 v3, 2208, v3
    v_add_u32 v16, v3, v2
    v_add_u32 v2, 64, v1
    v_mul_u32_u24 v3, 171, v2
    v_lshrrev_b32 v3, 10, v3
    v_lshlrev_b32 v2, 4, v2
    v_lshl_add_u32 v4, v3, 4, v2
    v_add_u32 v12, s70, v4
    v_mul_u32_u24 v3, 2208, v3
    v_add_u32 v17, v3, v2
    v_cmp_gt_u32 s[74:75], 32, v1
    v_mov_b32 v2, 2147483632
    s_nop 0
    v_cndmask_b32 v17, v2, v17, s[74:75]
    s_cmp_lg_u32 s3, 4
    s_cbranch_scc1 L_z2_44
    s_mov_b32 s87, 0
L_spin_84:
    buffer_load_dwordx2 v[244:245], v247, s[16:19], s88 offen sc1
    s_waitcnt vmcnt(0)
    v_cmp_ne_u64 vcc, v[250:251], v[244:245]
    s_add_u32 s87, s87, 1
    s_cbranch_vccz L_spun_85
    s_sleep 2
    s_cmp_lt_u32 s87, 65536
    s_cbranch_scc1 L_spin_84
L_spun_85:
L_z2_44:
    s_barrier
    buffer_load_dwordx4 v[20:23], v7, s[16:19], s64 offen offset:0 sc1
    buffer_load_dwordx4 v[24:27], v7, s[16:19], s64 offen offset:1024 sc1
    buffer_load_dwordx4 v[28:31], v7, s[16:19], s64 offen offset:2048 sc1
    buffer_load_dwordx4 v[32:35], v7, s[16:19], s64 offen offset:3072 sc1
    buffer_load_dwordx4 v[36:39], v7, s[16:19], s65 offen offset:0 sc1
    buffer_load_dwordx4 v[40:43], v7, s[16:19], s65 offen offset:1024 sc1
    buffer_load_dwordx4 v[44:47], v7, s[16:19], s65 offen offset:2048 sc1
    s_cmp_gt_u32 s3, 3
    s_cbranch_scc1 L_otail_86
    buffer_load_dwordx4 v[48:51], v7, s[16:19], s65 offen offset:3072 sc1
    buffer_load_dwordx4 v[52:55], v7, s[16:19], s66 offen offset:0 sc1
    s_branch L_oj_87
L_otail_86:
    buffer_load_dword v48, v6, s[16:19], s68 offen offset:0 sc1
    buffer_load_dword v49, v6, s[16:19], s68 offen offset:256 sc1
    buffer_load_dword v50, v6, s[16:19], s68 offen offset:512 sc1
    buffer_load_dword v51, v6, s[16:19], s68 offen offset:768 sc1
    buffer_load_dword v52, v6, s[16:19], s69 offen offset:0 sc1
    buffer_load_dword v53, v6, s[16:19], s69 offen offset:256 sc1
    buffer_load_dword v54, v6, s[16:19], s69 offen offset:512 sc1
    buffer_load_dword v55, v6, s[16:19], s69 offen offset:768 sc1
L_oj_87:
    s_waitcnt vmcnt(8) lgkmcnt(0)
    v_mfma_f32_16x16x32_bf16 v[200:203], v[56:59], v[20:23], 0
    ds_read_b64_tr_b16 v[56:57], v14 offset:36864
    ds_read_b64_tr_b16 v[58:59], v14 offset:37632
    v_mfma_f32_16x16x32_bf16 v[204:207], v[60:63], v[20:23], 0
    ds_read_b64_tr_b16 v[60:61], v15 offset:36896
    ds_read_b64_tr_b16 v[62:63], v15 offset:37664
    v_mfma_f32_16x16x32_bf16 v[208:211], v[64:67], v[20:23], 0
    ds_read_b64_tr_b16 v[64:65], v14 offset:36928
    ds_read_b64_tr_b16 v[66:67], v14 offset:37696
    v_mfma_f32_16x16x32_bf16 v[212:215], v[68:71], v[20:23], 0
    ds_read_b64_tr_b16 v[68:69], v15 offset:36960
    ds_read_b64_tr_b16 v[70:71], v15 offset:37728
    v_mfma_f32_16x16x32_bf16 v[216:219], v[72:75], v[20:23], 0
    ds_read_b64_tr_b16 v[72:73], v14 offset:36992
    ds_read_b64_tr_b16 v[74:75], v14 offset:37760
    v_mfma_f32_16x16x32_bf16 v[220:223], v[76:79], v[20:23], 0
    ds_read_b64_tr_b16 v[76:77], v15 offset:37024
    ds_read_b64_tr_b16 v[78:79], v15 offset:37792
    s_waitcnt vmcnt(7)
    v_mfma_f32_16x16x32_bf16 v[200:203], v[80:83], v[24:27], v[200:203]
    ds_read_b64_tr_b16 v[80:81], v14 offset:43008
    ds_read_b64_tr_b16 v[82:83], v14 offset:43776
    v_mfma_f32_16x16x32_bf16 v[204:207], v[84:87], v[24:27], v[204:207]
    ds_read_b64_tr_b16 v[84:85], v15 offset:43040
    ds_read_b64_tr_b16 v[86:87], v15 offset:43808
    v_mfma_f32_16x16x32_bf16 v[208:211], v[88:91], v[24:27], v[208:211]
    ds_read_b64_tr_b16 v[88:89], v14 offset:43072
    ds_read_b64_tr_b16 v[90:91], v14 offset:43840
    v_mfma_f32_16x16x32_bf16 v[212:215], v[92:95], v[24:27], v[212:215]
    ds_read_b64_tr_b16 v[92:93], v15 offset:43104
    ds_read_b64_tr_b16 v[94:95], v15 offset:43872
    v_mfma_f32_16x16x32_bf16 v[216:219], v[96:99], v[24:27], v[216:219]
    ds_read_b64_tr_b16 v[96:97], v14 offset:43136
    ds_read_b64_tr_b16 v[98:99], v14 offset:43904
    v_mfma_f32_16x16x32_bf16 v[220:223], v[100:103], v[24:27], v[220:223]
    ds_read_b64_tr_b16 v[100:101], v15 offset:43168
    ds_read_b64_tr_b16 v[102:103], v15 offset:43936
    s_waitcnt vmcnt(6)
    v_mfma_f32_16x16x32_bf16 v[200:203], v[104:107], v[28:31], v[200:203]
    ds_read_b64_tr_b16 v[104:105], v14 offset:49152
    ds_read_b64_tr_b16 v[106:107], v14 offset:49920
    v_mfma_f32_16x16x32_bf16 v[204:207], v[108:111], v[28:31], v[204:207]
    ds_read_b64_tr_b16 v[108:109], v15 offset:49184
    ds_read_b64_tr_b16 v[110:111], v15 offset:49952
    v_mfma_f32_16x16x32_bf16 v[208:211], v[112:115], v[28:31], v[208:211]
    ds_read_b64_tr_b16 v[112:113], v14 offset:49216
    ds_read_b64_tr_b16 v[114:115], v14 offset:49984
    v_mfma_f32_16x16x32_bf16 v[212:215], v[116:119], v[28:31], v[212:215]
    ds_read_b64_tr_b16 v[116:117], v15 offset:49248
    ds_read_b64_tr_b16 v[118:119], v15 offset:50016
    v_mfma_f32_16x16x32_bf16 v[216:219], v[120:123], v[28:31], v[216:219]
    ds_read_b64_tr_b16 v[120:121], v14 offset:49280
    ds_read_b64_tr_b16 v[122:123], v14 offset:50048
    v_mfma_f32_16x16x32_bf16 v[220:223], v[124:127], v[28:31], v[220:223]
    ds_read_b64_tr_b16 v[124:125], v15 offset:49312
    ds_read_b64_tr_b16 v[126:127], v15 offset:50080
    s_waitcnt vmcnt(5)
    v_mfma_f32_16x16x32_bf16 v[200:203], v[128:131], v[32:35], v[200:203]
    v_mfma_f32_16x16x32_bf16 v[204:207], v[132:135], v[32:35], v[204:207]
    v_mfma_f32_16x16x32_bf16 v[208:211], v[136:139], v[32:35], v[208:211]
    v_mfma_f32_16x16x32_bf16 v[212:215], v[140:143], v[32:35], v[212:215]
    v_mfma_f32_16x16x32_bf16 v[216:219], v[144:147], v[32:35], v[216:219]
    v_mfma_f32_16x16x32_bf16 v[220:223], v[148:151], v[32:35], v[220:223]
    s_waitcnt vmcnt(4)
    v_mfma_f32_16x16x32_bf16 v[200:203], v[152:155], v[36:39], v[200:203]
    v_mfma_f32_16x16x32_bf16 v[204:207], v[156:159], v[36:39], v[204:207]
    v_mfma_f32_16x16x32_bf16 v[208:211], v[160:163], v[36:39], v[208:211]
    v_mfma_f32_16x16x32_bf16 v[212:215], v[164:167], v[36:39], v[212:215]
    v_mfma_f32_16x16x32_bf16 v[216:219], v[168:171], v[36:39], v[216:219]
    v_mfma_f32_16x16x32_bf16 v[220:223], v[172:175], v[36:39], v[220:223]
    s_waitcnt vmcnt(3)
    v_mfma_f32_16x16x32_bf16 v[200:203], v[176:179], v[40:43], v[200:203]
    v_mfma_f32_16x16x32_bf16 v[204:207], v[180:183], v[40:43], v[204:207]
    v_mfma_f32_16x16x32_bf16 v[208:211], v[184:187], v[40:43], v[208:211]
    v_mfma_f32_16x16x32_bf16 v[212:215], v[188:191], v[40:43], v[212:215]
    v_mfma_f32_16x16x32_bf16 v[216:219], v[192:195], v[40:43], v[216:219]
    v_mfma_f32_16x16x32_bf16 v[220:223], v[196:199], v[40:43], v[220:223]
    s_waitcnt vmcnt(2) lgkmcnt(0)
    v_mfma_f32_16x16x32_bf16 v[200:203], v[56:59], v[44:47], v[200:203]
    v_mfma_f32_16x16x32_bf16 v[204:207], v[60:63], v[44:47], v[204:207]
    v_mfma_f32_16x16x32_bf16 v[208:211], v[64:67], v[44:47], v[208:211]
    v_mfma_f32_16x16x32_bf16 v[212:215], v[68:71], v[44:47], v[212:215]
    v_mfma_f32_16x16x32_bf16 v[216:219], v[72:75], v[44:47], v[216:219]
    v_mfma_f32_16x16x32_bf16 v[220:223], v[76:79], v[44:47], v[220:223]
    s_waitcnt vmcnt(0)
    v_mfma_f32_16x16x32_bf16 v[200:203], v[80:83], v[48:51], v[200:203]
    v_mfma_f32_16x16x32_bf16 v[204:207], v[84:87], v[48:51], v[204:207]
    v_mfma_f32_16x16x32_bf16 v[208:211], v[88:91], v[48:51], v[208:211]
    v_mfma_f32_16x16x32_bf16 v[212:215], v[92:95], v[48:51], v[212:215]
    v_mfma_f32_16x16x32_bf16 v[216:219], v[96:99], v[48:51], v[216:219]
    v_mfma_f32_16x16x32_bf16 v[220:223], v[100:103], v[48:51], v[220:223]
    s_waitcnt vmcnt(0)
    v_mfma_f32_16x16x32_bf16 v[200:203], v[104:107], v[52:55], v[200:203]
    v_mfma_f32_16x16x32_bf16 v[204:207], v[108:111], v[52:55], v[204:207]
    v_mfma_f32_16x16x32_bf16 v[208:211], v[112:115], v[52:55], v[208:211]
    v_mfma_f32_16x16x32_bf16 v[212:215], v[116:119], v[52:55], v[212:215]
    v_mfma_f32_16x16x32_bf16 v[216:219], v[120:123], v[52:55], v[216:219]
    v_mfma_f32_16x16x32_bf16 v[220:223], v[124:127], v[52:55], v[220:223]
    s_cmp_gt_u32 s3, 3
    s_cbranch_scc1 L_kh1_88
    s_nop 5
    ds_write_b128 v8, v[212:215] offset:0
    ds_write_b128 v8, v[216:219] offset:1024
    ds_write_b128 v8, v[220:223] offset:2048
    s_waitcnt lgkmcnt(0)
    s_barrier
    ds_read_b128 v[56:59], v9 offset:0
    ds_read_b128 v[60:63], v9 offset:1024
    ds_read_b128 v[64:67], v9 offset:2048
    s_waitcnt lgkmcnt(2)
    v_add_f32 v200, v200, v56
    v_add_f32 v201, v201, v57
    v_add_f32 v202, v202, v58
    v_add_f32 v203, v203, v59
    v_cvt_pk_bf16_f32 v80, v200, v201
    v_cvt_pk_bf16_f32 v81, v202, v203
    ds_write_b64 v10, v[80:81] offset:0
    s_waitcnt lgkmcnt(2)
    v_add_f32 v204, v204, v60
    v_add_f32 v205, v205, v61
    v_add_f32 v206, v206, v62
    v_add_f32 v207, v207, v63
    v_cvt_pk_bf16_f32 v84, v204, v205
    v_cvt_pk_bf16_f32 v85, v206, v207
    ds_write_b64 v10, v[84:85] offset:32
    s_waitcnt lgkmcnt(2)
    v_add_f32 v208, v208, v64
    v_add_f32 v209, v209, v65
    v_add_f32 v210, v210, v66
    v_add_f32 v211, v211, v67
    v_cvt_pk_bf16_f32 v88, v208, v209
    v_cvt_pk_bf16_f32 v89, v210, v211
    ds_write_b64 v10, v[88:89] offset:64
    s_branch L_khj_89
L_kh1_88:
    s_nop 2
    ds_write_b128 v8, v[200:203] offset:0
    ds_write_b128 v8, v[204:207] offset:1024
    ds_write_b128 v8, v[208:211] offset:2048
    s_waitcnt lgkmcnt(0)
    s_barrier
    ds_read_b128 v[56:59], v9 offset:0
    ds_read_b128 v[60:63], v9 offset:1024
    ds_read_b128 v[64:67], v9 offset:2048
    s_waitcnt lgkmcnt(2)
    v_add_f32 v212, v212, v56
    v_add_f32 v213, v213, v57
    v_add_f32 v214, v214, v58
    v_add_f32 v215, v215, v59
    v_cvt_pk_bf16_f32 v80, v212, v213
    v_cvt_pk_bf16_f32 v81, v214, v215
    ds_write_b64 v10, v[80:81] offset:0
    s_waitcnt lgkmcnt(2)
    v_add_f32 v216, v216, v60
    v_add_f32 v217, v217, v61
    v_add_f32 v218, v218, v62
    v_add_f32 v219, v219, v63
    v_cvt_pk_bf16_f32 v84, v216, v217
    v_cvt_pk_bf16_f32 v85, v218, v219
    ds_write_b64 v10, v[84:85] offset:32
    s_waitcnt lgkmcnt(2)
    v_add_f32 v220, v220, v64
    v_add_f32 v221, v221, v65
    v_add_f32 v222, v222, v66
    v_add_f32 v223, v223, v67
    v_cvt_pk_bf16_f32 v88, v220, v221
    v_cvt_pk_bf16_f32 v89, v222, v223
    ds_write_b64 v10, v[88:89] offset:64
L_khj_89:
    ds_read_b128 v[104:107], v11
    ds_read_b128 v[108:111], v12
    s_waitcnt lgkmcnt(1)
    buffer_store_dwordx4 v[104:107], v16, s[20:23], s72 offen sc1
    s_waitcnt lgkmcnt(0)
    buffer_store_dwordx4 v[108:111], v17, s[20:23], s72 offen sc1
L_end:
    s_endpgm
L_abar_56:
    ds_read_b32 v20, v17
    s_waitcnt lgkmcnt(0)
    v_cmp_gt_u32 vcc, s80, v20
    s_nop 0
    s_cbranch_vccnz L_abar_56
    s_branch L_aback_57
L_aout2_55:
    s_barrier
    s_branch L_aout_54
L_aredo_52:
    s_barrier
    v_subrev_u32 v2, 151552, v2
    v_subrev_u32 v3, 151552, v3
    v_subrev_u32 v4, 151552, v4
    v_subrev_u32 v5, 151552, v5
    v_mov_b32 v6, 0xff800000
    v_mov_b32 v7, 0xff800000
    s_mov_b32 s67, 0
L_amax_90:
    ds_read_b128 v[48:51], v2 offset:0
    ds_read_b64 v[72:73], v3 offset:0
    s_waitcnt lgkmcnt(0)
    v_mfma_f32_32x32x16_bf16 v[88:103], v[48:51], v[24:27], 0
    v_mfma_f32_32x32x8_bf16 v[88:103], v[72:73], v[32:33], v[88:103]
    v_mfma_f32_32x32x16_bf16 v[104:119], v[48:51], v[28:31], 0
    v_mfma_f32_32x32x8_bf16 v[104:119], v[72:73], v[40:41], v[104:119]
    s_nop 11
    v_max3_f32 v6, v6, v88, v89
    v_max3_f32 v6, v6, v90, v91
    v_max3_f32 v6, v6, v92, v93
    v_max3_f32 v6, v6, v94, v95
    v_max3_f32 v6, v6, v96, v97
    v_max3_f32 v6, v6, v98, v99
    v_max3_f32 v6, v6, v100, v101
    v_max3_f32 v6, v6, v102, v103
    v_max3_f32 v7, v7, v104, v105
    v_max3_f32 v7, v7, v106, v107
    v_max3_f32 v7, v7, v108, v109
    v_max3_f32 v7, v7, v110, v111
    v_max3_f32 v7, v7, v112, v113
    v_max3_f32 v7, v7, v114, v115
    v_max3_f32 v7, v7, v116, v117
    v_max3_f32 v7, v7, v118, v119
    ds_read_b128 v[52:55], v2 offset:1024
    s_waitcnt lgkmcnt(0)
    v_mfma_f32_32x32x16_bf16 v[88:103], v[52:55], v[24:27], 0
    v_mfma_f32_32x32x8_bf16 v[88:103], v[72:73], v[34:35], v[88:103]
    v_mfma_f32_32x32x16_bf16 v[104:119], v[52:55], v[28:31], 0
    v_mfma_f32_32x32x8_bf16 v[104:119], v[72:73], v[42:43], v[104:119]
    s_nop 11
    v_max3_f32 v6, v6, v88, v89
    v_max3_f32 v6, v6, v90, v91
    v_max3_f32 v6, v6, v92, v93
    v_max3_f32 v6, v6, v94, v95
    v_max3_f32 v6, v6, v96, v97
    v_max3_f32 v6, v6, v98, v99
    v_max3_f32 v6, v6, v100, v101
    v_max3_f32 v6, v6, v102, v103
    v_max3_f32 v7, v7, v104, v105
    v_max3_f32 v7, v7, v106, v107
    v_max3_f32 v7, v7, v108, v109
    v_max3_f32 v7, v7, v110, v111
    v_max3_f32 v7, v7, v112, v113
    v_max3_f32 v7, v7, v114, v115
    v_max3_f32 v7, v7, v116, v117
    v_max3_f32 v7, v7, v118, v119
    ds_read_b128 v[48:51], v2 offset:2048
    s_waitcnt lgkmcnt(0)
    v_mfma_f32_32x32x16_bf16 v[88:103], v[48:51], v[24:27], 0
    v_mfma_f32_32x32x8_bf16 v[88:103], v[72:73], v[36:37], v[88:103]
    v_mfma_f32_32x32x16_bf16 v[104:119], v[48:51], v[28:31], 0
    v_mfma_f32_32x32x8_bf16 v[104:119], v[72:73], v[44:45], v[104:119]
    s_nop 11
    v_max3_f32 v6, v6, v88, v89
    v_max3_f32 v6, v6, v90, v91
    v_max3_f32 v6, v6, v92, v93
    v_max3_f32 v6, v6, v94, v95
    v_max3_f32 v6, v6, v96, v97
    v_max3_f32 v6, v6, v98, v99
    v_max3_f32 v6, v6, v100, v101
    v_max3_f32 v6, v6, v102, v103
    v_max3_f32 v7, v7, v104, v105
    v_max3_f32 v7, v7, v106, v107
    v_max3_f32 v7, v7, v108, v109
    v_max3_f32 v7, v7, v110, v111
    v_max3_f32 v7, v7, v112, v113
    v_max3_f32 v7, v7, v114, v115
    v_max3_f32 v7, v7, v116, v117
    v_max3_f32 v7, v7, v118, v119
    ds_read_b128 v[52:55], v2 offset:3072
    s_waitcnt lgkmcnt(0)
    v_mfma_f32_32x32x16_bf16 v[88:103], v[52:55], v[24:27], 0
    v_mfma_f32_32x32x8_bf16 v[88:103], v[72:73], v[38:39], v[88:103]
    v_mfma_f32_32x32x16_bf16 v[104:119], v[52:55], v[28:31], 0
    v_mfma_f32_32x32x8_bf16 v[104:119], v[72:73], v[46:47], v[104:119]
    s_nop 11
    v_max3_f32 v6, v6, v88, v89
    v_max3_f32 v6, v6, v90, v91
    v_max3_f32 v6, v6, v92, v93
    v_max3_f32 v6, v6, v94, v95
    v_max3_f32 v6, v6, v96, v97
    v_max3_f32 v6, v6, v98, v99
    v_max3_f32 v6, v6, v100, v101
    v_max3_f32 v6, v6, v102, v103
    v_max3_f32 v7, v7, v104, v105
    v_max3_f32 v7, v7, v106, v107
    v_max3_f32 v7, v7, v108, v109
    v_max3_f32 v7, v7, v110, v111
    v_max3_f32 v7, v7, v112, v113
    v_max3_f32 v7, v7, v114, v115
    v_max3_f32 v7, v7, v116, v117
    v_max3_f32 v7, v7, v118, v119
    ds_read_b128 v[48:51], v2 offset:4096
    ds_read_b64 v[74:75], v3 offset:512
    s_waitcnt lgkmcnt(0)
    v_mfma_f32_32x32x16_bf16 v[88:103], v[48:51], v[24:27], 0
    v_mfma_f32_32x32x8_bf16 v[88:103], v[74:75], v[32:33], v[88:103]
    v_mfma_f32_32x32x16_bf16 v[104:119], v[48:51], v[28:31], 0
    v_mfma_f32_32x32x8_bf16 v[104:119], v[74:75], v[40:41], v[104:119]
    s_nop 11
    v_max3_f32 v6, v6, v88, v89
    v_max3_f32 v6, v6, v90, v91
    v_max3_f32 v6, v6, v92, v93
    v_max3_f32 v6, v6, v94, v95
    v_max3_f32 v6, v6, v96, v97
    v_max3_f32 v6, v6, v98, v99
    v_max3_f32 v6, v6, v100, v101
    v_max3_f32 v6, v6, v102, v103
    v_max3_f32 v7, v7, v104, v105
    v_max3_f32 v7, v7, v106, v107
    v_max3_f32 v7, v7, v108, v109
    v_max3_f32 v7, v7, v110, v111
    v_max3_f32 v7, v7, v112, v113
    v_max3_f32 v7, v7, v114, v115
    v_max3_f32 v7, v7, v116, v117
    v_max3_f32 v7, v7, v118, v119
    ds_read_b128 v[52:55], v2 offset:5120
    s_waitcnt lgkmcnt(0)
    v_mfma_f32_32x32x16_bf16 v[88:103], v[52:55], v[24:27], 0
    v_mfma_f32_32x32x8_bf16 v[88:103], v[74:75], v[34:35], v[88:103]
    v_mfma_f32_32x32x16_bf16 v[104:119], v[52:55], v[28:31], 0
    v_mfma_f32_32x32x8_bf16 v[104:119], v[74:75], v[42:43], v[104:119]
    s_nop 11
    v_max3_f32 v6, v6, v88, v89
    v_max3_f32 v6, v6, v90, v91
    v_max3_f32 v6, v6, v92, v93
    v_max3_f32 v6, v6, v94, v95
    v_max3_f32 v6, v6, v96, v97
    v_max3_f32 v6, v6, v98, v99
    v_max3_f32 v6, v6, v100, v101
    v_max3_f32 v6, v6, v102, v103
    v_max3_f32 v7, v7, v104, v105
    v_max3_f32 v7, v7, v106, v107
    v_max3_f32 v7, v7, v108, v109
    v_max3_f32 v7, v7, v110, v111
    v_max3_f32 v7, v7, v112, v113
    v_max3_f32 v7, v7, v114, v115
    v_max3_f32 v7, v7, v116, v117
    v_max3_f32 v7, v7, v118, v119
    ds_read_b128 v[48:51], v2 offset:6144
    s_waitcnt lgkmcnt(0)
    v_mfma_f32_32x32x16_bf16 v[88:103], v[48:51], v[24:27], 0
    v_mfma_f32_32x32x8_bf16 v[88:103], v[74:75], v[36:37], v[88:103]
    v_mfma_f32_32x32x16_bf16 v[104:119], v[48:51], v[28:31], 0
    v_mfma_f32_32x32x8_bf16 v[104:119], v[74:75], v[44:45], v[104:119]
    s_nop 11
    v_max3_f32 v6, v6, v88, v89
    v_max3_f32 v6, v6, v90, v91
    v_max3_f32 v6, v6, v92, v93
    v_max3_f32 v6, v6, v94, v95
    v_max3_f32 v6, v6, v96, v97
    v_max3_f32 v6, v6, v98, v99
    v_max3_f32 v6, v6, v100, v101
    v_max3_f32 v6, v6, v102, v103
    v_max3_f32 v7, v7, v104, v105
    v_max3_f32 v7, v7, v106, v107
    v_max3_f32 v7, v7, v108, v109
    v_max3_f32 v7, v7, v110, v111
    v_max3_f32 v7, v7, v112, v113
    v_max3_f32 v7, v7, v114, v115
    v_max3_f32 v7, v7, v116, v117
    v_max3_f32 v7, v7, v118, v119
    ds_read_b128 v[52:55], v2 offset:7168
    s_waitcnt lgkmcnt(0)
    v_mfma_f32_32x32x16_bf16 v[88:103], v[52:55], v[24:27], 0
    v_mfma_f32_32x32x8_bf16 v[88:103], v[74:75], v[38:39], v[88:103]
    v_mfma_f32_32x32x16_bf16 v[104:119], v[52:55], v[28:31], 0
    v_mfma_f32_32x32x8_bf16 v[104:119], v[74:75], v[46:47], v[104:119]
    s_nop 11
    v_max3_f32 v6, v6, v88, v89
    v_max3_f32 v6, v6, v90, v91
    v_max3_f32 v6, v6, v92, v93
    v_max3_f32 v6, v6, v94, v95
    v_max3_f32 v6, v6, v96, v97
    v_max3_f32 v6, v6, v98, v99
    v_max3_f32 v6, v6, v100, v101
    v_max3_f32 v6, v6, v102, v103
    v_max3_f32 v7, v7, v104, v105
    v_max3_f32 v7, v7, v106, v107
    v_max3_f32 v7, v7, v108, v109
    v_max3_f32 v7, v7, v110, v111
    v_max3_f32 v7, v7, v112, v113
    v_max3_f32 v7, v7, v114, v115
    v_max3_f32 v7, v7, v116, v117
    v_max3_f32 v7, v7, v118, v119
    v_add_u32 v2, 18944, v2
    v_add_u32 v3, 18944, v3
    s_add_u32 s67, s67, 1
    s_cmp_lt_u32 s67, 8
    s_cbranch_scc1 L_amax_90
    v_mov_b32 v8, v6
    v_mov_b32 v9, v7
    v_subrev_u32 v2, 151552, v2
    v_subrev_u32 v3, 151552, v3
    v_permlane32_swap_b32 v6, v8
    v_permlane32_swap_b32 v7, v9
    s_mov_b32 s68, 16
    v_max_f32 v6, v6, v8
    v_max_f32 v7, v7, v9
    v_sub_f32 v152, 0, v6
    v_sub_f32 v153, 0, v6
    v_sub_f32 v154, 0, v6
    v_sub_f32 v155, 0, v6
    v_sub_f32 v156, 0, v6
    v_sub_f32 v157, 0, v6
    v_sub_f32 v158, 0, v6
    v_sub_f32 v159, 0, v6
    v_sub_f32 v160, 0, v6
    v_sub_f32 v161, 0, v6
    v_sub_f32 v162, 0, v6
    v_sub_f32 v163, 0, v6
    v_sub_f32 v164, 0, v6
    v_sub_f32 v165, 0, v6
    v_sub_f32 v166, 0, v6
    v_sub_f32 v167, 0, v6
    v_sub_f32 v168, 0, v7
    v_sub_f32 v169, 0, v7
    v_sub_f32 v170, 0, v7
    v_sub_f32 v171, 0, v7
    v_sub_f32 v172, 0, v7
    v_sub_f32 v173, 0, v7
    v_sub_f32 v174, 0, v7
    v_sub_f32 v175, 0, v7
    v_sub_f32 v176, 0, v7
    v_sub_f32 v177, 0, v7
    v_sub_f32 v178, 0, v7
    v_sub_f32 v179, 0, v7
    v_sub_f32 v180, 0, v7
    v_sub_f32 v181, 0, v7
    v_sub_f32 v182, 0, v7
    v_sub_f32 v183, 0, v7
    v_mov_b32 v120, 0
    v_mov_b32 v121, 0
    v_mov_b32 v122, 0
    v_mov_b32 v123, 0
    v_mov_b32 v124, 0
    v_mov_b32 v125, 0
    v_mov_b32 v126, 0
    v_mov_b32 v127, 0
    v_mov_b32 v128, 0
    v_mov_b32 v129, 0
    v_mov_b32 v130, 0
    v_mov_b32 v131, 0
    v_mov_b32 v132, 0
    v_mov_b32 v133, 0
    v_mov_b32 v134, 0
    v_mov_b32 v135, 0
    v_mov_b32 v136, 0
    v_mov_b32 v137, 0
    v_mov_b32 v138, 0
    v_mov_b32 v139, 0
    v_mov_b32 v140, 0
    v_mov_b32 v141, 0
    v_mov_b32 v142, 0
    v_mov_b32 v143, 0
    v_mov_b32 v144, 0
    v_mov_b32 v145, 0
    v_mov_b32 v146, 0
    v_mov_b32 v147, 0
    v_mov_b32 v148, 0
    v_mov_b32 v149, 0
    v_mov_b32 v150, 0
    v_mov_b32 v151, 0
    v_mov_b32 v68, 0
    v_mov_b32 v84, 0
    v_mov_b32 v69, 0
    v_mov_b32 v85, 0
    v_mov_b32 v70, 0
    v_mov_b32 v86, 0
    v_mov_b32 v71, 0
    v_mov_b32 v87, 0
    v_mov_b32 v78, 0
    v_mov_b32 v79, 0
    s_mov_b32 s67, 0
    ds_read_b128 v[48:51], v2 offset:0
    ds_read_b64 v[72:73], v3 offset:0
    ds_read_b128 v[56:59], v4 offset:0
    ds_read_b128 v[52:55], v2 offset:1024
    ds_read_b128 v[64:67], v5 offset:0
    ds_read_b128 v[60:63], v4 offset:1216
    s_waitcnt lgkmcnt(3)
    v_mfma_f32_32x32x16_bf16 v[88:103], v[48:51], v[24:27], v[152:167]
    v_mfma_f32_32x32x8_bf16 v[88:103], v[72:73], v[32:33], v[88:103]
    s_nop 7
    s_nop 2
.p2align 6
L_aloop_91:
    v_mfma_f32_32x32x16_bf16 v[104:119], v[48:51], v[28:31], v[168:183]
    v_exp_f32 v76, v88
    v_cvt_pk_bf16_f32 v87, v78, v79
    v_exp_f32 v77, v89
    v_exp_f32 v78, v90
    v_cvt_pk_bf16_f32 v80, v76, v77
    v_exp_f32 v79, v91
    v_mfma_f32_32x32x8_bf16 v[104:119], v[72:73], v[40:41], v[104:119]
    v_exp_f32 v76, v92
    v_cvt_pk_bf16_f32 v81, v78, v79
    v_exp_f32 v77, v93
    v_exp_f32 v78, v94
    v_cvt_pk_bf16_f32 v82, v76, v77
    v_exp_f32 v79, v95
    v_mfma_f32_32x32x16_bf16 v[136:151], v[68:71], v[84:87], v[136:151]
    v_exp_f32 v76, v96
    v_cvt_pk_bf16_f32 v83, v78, v79
    v_exp_f32 v77, v97
    v_exp_f32 v78, v98
    v_cvt_pk_bf16_f32 v84, v76, v77
    v_exp_f32 v79, v99
    v_mfma_f32_32x32x16_bf16 v[120:135], v[56:59], v[80:83], v[120:135]
    s_waitcnt lgkmcnt(0)
    v_exp_f32 v76, v100
    v_cvt_pk_bf16_f32 v85, v78, v79
    v_exp_f32 v77, v101
    v_exp_f32 v78, v102
    v_cvt_pk_bf16_f32 v86, v76, v77
    v_exp_f32 v79, v103
    v_mfma_f32_32x32x16_bf16 v[88:103], v[52:55], v[24:27], v[152:167]
    ds_read_b128 v[48:51], v2 offset:2048
    v_exp_f32 v76, v104
    v_cvt_pk_bf16_f32 v87, v78, v79
    v_exp_f32 v77, v105
    v_exp_f32 v78, v106
    v_cvt_pk_bf16_f32 v80, v76, v77
    v_exp_f32 v79, v107
    v_mfma_f32_32x32x8_bf16 v[88:103], v[72:73], v[34:35], v[88:103]
    v_exp_f32 v76, v108
    v_cvt_pk_bf16_f32 v81, v78, v79
    v_exp_f32 v77, v109
    v_exp_f32 v78, v110
    v_cvt_pk_bf16_f32 v82, v76, v77
    v_exp_f32 v79, v111
    v_mfma_f32_32x32x16_bf16 v[120:135], v[64:67], v[84:87], v[120:135]
    ds_read_b128 v[68:71], v5 offset:1216
    v_exp_f32 v76, v112
    v_cvt_pk_bf16_f32 v83, v78, v79
    v_exp_f32 v77, v113
    v_exp_f32 v78, v114
    v_cvt_pk_bf16_f32 v84, v76, v77
    v_exp_f32 v79, v115
    v_mfma_f32_32x32x16_bf16 v[136:151], v[56:59], v[80:83], v[136:151]
    ds_read_b128 v[56:59], v4 offset:2432
    v_exp_f32 v76, v116
    v_cvt_pk_bf16_f32 v85, v78, v79
    v_exp_f32 v77, v117
    v_exp_f32 v78, v118
    v_cvt_pk_bf16_f32 v86, v76, v77
    v_exp_f32 v79, v119
    v_mfma_f32_32x32x16_bf16 v[104:119], v[52:55], v[28:31], v[168:183]
    v_exp_f32 v76, v88
    v_cvt_pk_bf16_f32 v87, v78, v79
    v_exp_f32 v77, v89
    v_exp_f32 v78, v90
    v_cvt_pk_bf16_f32 v80, v76, v77
    v_exp_f32 v79, v91
    v_mfma_f32_32x32x8_bf16 v[104:119], v[72:73], v[42:43], v[104:119]
    v_exp_f32 v76, v92
    v_cvt_pk_bf16_f32 v81, v78, v79
    v_exp_f32 v77, v93
    v_exp_f32 v78, v94
    v_cvt_pk_bf16_f32 v82, v76, v77
    v_exp_f32 v79, v95
    v_mfma_f32_32x32x16_bf16 v[136:151], v[64:67], v[84:87], v[136:151]
    v_exp_f32 v76, v96
    v_cvt_pk_bf16_f32 v83, v78, v79
    v_exp_f32 v77, v97
    v_exp_f32 v78, v98
    v_cvt_pk_bf16_f32 v84, v76, v77
    v_exp_f32 v79, v99
    v_mfma_f32_32x32x16_bf16 v[120:135], v[60:63], v[80:83], v[120:135]
    s_waitcnt lgkmcnt(0)
    v_exp_f32 v76, v100
    v_cvt_pk_bf16_f32 v85, v78, v79
    v_exp_f32 v77, v101
    v_exp_f32 v78, v102
    v_cvt_pk_bf16_f32 v86, v76, v77
    v_exp_f32 v79, v103
    v_mfma_f32_32x32x16_bf16 v[88:103], v[48:51], v[24:27], v[152:167]
    ds_read_b128 v[52:55], v2 offset:3072
    v_exp_f32 v76, v104
    v_cvt_pk_bf16_f32 v87, v78, v79
    v_exp_f32 v77, v105
    v_exp_f32 v78, v106
    v_cvt_pk_bf16_f32 v80, v76, v77
    v_exp_f32 v79, v107
    v_mfma_f32_32x32x8_bf16 v[88:103], v[72:73], v[36:37], v[88:103]
    ds_read_b64 v[74:75], v3 offset:512
    v_exp_f32 v76, v108
    v_cvt_pk_bf16_f32 v81, v78, v79
    v_exp_f32 v77, v109
    v_exp_f32 v78, v110
    v_cvt_pk_bf16_f32 v82, v76, v77
    v_exp_f32 v79, v111
    v_mfma_f32_32x32x16_bf16 v[120:135], v[68:71], v[84:87], v[120:135]
    ds_read_b128 v[64:67], v5 offset:2432
    v_exp_f32 v76, v112
    v_cvt_pk_bf16_f32 v83, v78, v79
    v_exp_f32 v77, v113
    v_exp_f32 v78, v114
    v_cvt_pk_bf16_f32 v84, v76, v77
    v_exp_f32 v79, v115
    v_mfma_f32_32x32x16_bf16 v[136:151], v[60:63], v[80:83], v[136:151]
    ds_read_b128 v[60:63], v4 offset:3648
    v_exp_f32 v76, v116
    v_cvt_pk_bf16_f32 v85, v78, v79
    v_exp_f32 v77, v117
    v_exp_f32 v78, v118
    v_cvt_pk_bf16_f32 v86, v76, v77
    v_exp_f32 v79, v119
    v_mfma_f32_32x32x16_bf16 v[104:119], v[48:51], v[28:31], v[168:183]
    v_exp_f32 v76, v88
    v_cvt_pk_bf16_f32 v87, v78, v79
    v_exp_f32 v77, v89
    v_exp_f32 v78, v90
    v_cvt_pk_bf16_f32 v80, v76, v77
    v_exp_f32 v79, v91
    v_mfma_f32_32x32x8_bf16 v[104:119], v[72:73], v[44:45], v[104:119]
    v_exp_f32 v76, v92
    v_cvt_pk_bf16_f32 v81, v78, v79
    v_exp_f32 v77, v93
    v_exp_f32 v78, v94
    v_cvt_pk_bf16_f32 v82, v76, v77
    v_exp_f32 v79, v95
    v_mfma_f32_32x32x16_bf16 v[136:151], v[68:71], v[84:87], v[136:151]
    v_exp_f32 v76, v96
    v_cvt_pk_bf16_f32 v83, v78, v79
    v_exp_f32 v77, v97
    v_exp_f32 v78, v98
    v_cvt_pk_bf16_f32 v84, v76, v77
    v_exp_f32 v79, v99
    v_mfma_f32_32x32x16_bf16 v[120:135], v[56:59], v[80:83], v[120:135]
    s_waitcnt lgkmcnt(0)
    v_exp_f32 v76, v100
    v_cvt_pk_bf16_f32 v85, v78, v79
    v_exp_f32 v77, v101
    v_exp_f32 v78, v102
    v_cvt_pk_bf16_f32 v86, v76, v77
    v_exp_f32 v79, v103
    v_mfma_f32_32x32x16_bf16 v[88:103], v[52:55], v[24:27], v[152:167]
    ds_read_b128 v[48:51], v2 offset:4096
    v_exp_f32 v76, v104
    v_cvt_pk_bf16_f32 v87, v78, v79
    v_exp_f32 v77, v105
    v_exp_f32 v78, v106
    v_cvt_pk_bf16_f32 v80, v76, v77
    v_exp_f32 v79, v107
    v_mfma_f32_32x32x8_bf16 v[88:103], v[72:73], v[38:39], v[88:103]
    v_exp_f32 v76, v108
    v_cvt_pk_bf16_f32 v81, v78, v79
    v_exp_f32 v77, v109
    v_exp_f32 v78, v110
    v_cvt_pk_bf16_f32 v82, v76, v77
    v_exp_f32 v79, v111
    v_mfma_f32_32x32x16_bf16 v[120:135], v[64:67], v[84:87], v[120:135]
    ds_read_b128 v[68:71], v5 offset:3648
    v_exp_f32 v76, v112
    v_cvt_pk_bf16_f32 v83, v78, v79
    v_exp_f32 v77, v113
    v_exp_f32 v78, v114
    v_cvt_pk_bf16_f32 v84, v76, v77
    v_exp_f32 v79, v115
    v_mfma_f32_32x32x16_bf16 v[136:151], v[56:59], v[80:83], v[136:151]
    ds_read_b128 v[56:59], v4 offset:4864
    v_exp_f32 v76, v116
    v_cvt_pk_bf16_f32 v85, v78, v79
    v_exp_f32 v77, v117
    v_exp_f32 v78, v118
    v_cvt_pk_bf16_f32 v86, v76, v77
    v_exp_f32 v79, v119
    v_mfma_f32_32x32x16_bf16 v[104:119], v[52:55], v[28:31], v[168:183]
    v_exp_f32 v76, v88
    v_cvt_pk_bf16_f32 v87, v78, v79
    v_exp_f32 v77, v89
    v_exp_f32 v78, v90
    v_cvt_pk_bf16_f32 v80, v76, v77
    v_exp_f32 v79, v91
    v_mfma_f32_32x32x8_bf16 v[104:119], v[72:73], v[46:47], v[104:119]
    v_exp_f32 v76, v92
    v_cvt_pk_bf16_f32 v81, v78, v79
    v_exp_f32 v77, v93
    v_exp_f32 v78, v94
    v_cvt_pk_bf16_f32 v82, v76, v77
    v_exp_f32 v79, v95
    v_mfma_f32_32x32x16_bf16 v[136:151], v[64:67], v[84:87], v[136:151]
    v_exp_f32 v76, v96
    v_cvt_pk_bf16_f32 v83, v78, v79
    v_exp_f32 v77, v97
    v_exp_f32 v78, v98
    v_cvt_pk_bf16_f32 v84, v76, v77
    v_exp_f32 v79, v99
    v_mfma_f32_32x32x16_bf16 v[120:135], v[60:63], v[80:83], v[120:135]
    s_waitcnt lgkmcnt(0)
    v_exp_f32 v76, v100
    v_cvt_pk_bf16_f32 v85, v78, v79
    v_exp_f32 v77, v101
    v_exp_f32 v78, v102
    v_cvt_pk_bf16_f32 v86, v76, v77
    v_exp_f32 v79, v103
    v_mfma_f32_32x32x16_bf16 v[88:103], v[48:51], v[24:27], v[152:167]
    ds_read_b128 v[52:55], v2 offset:5120
    v_exp_f32 v76, v104
    v_cvt_pk_bf16_f32 v87, v78, v79
    v_exp_f32 v77, v105
    v_exp_f32 v78, v106
    v_cvt_pk_bf16_f32 v80, v76, v77
    v_exp_f32 v79, v107
    v_mfma_f32_32x32x8_bf16 v[88:103], v[74:75], v[32:33], v[88:103]
    v_exp_f32 v76, v108
    v_cvt_pk_bf16_f32 v81, v78, v79
    v_exp_f32 v77, v109
    v_exp_f32 v78, v110
    v_cvt_pk_bf16_f32 v82, v76, v77
    v_exp_f32 v79, v111
    v_mfma_f32_32x32x16_bf16 v[120:135], v[68:71], v[84:87], v[120:135]
    ds_read_b128 v[64:67], v5 offset:4864
    v_exp_f32 v76, v112
    v_cvt_pk_bf16_f32 v83, v78, v79
    v_exp_f32 v77, v113
    v_exp_f32 v78, v114
    v_cvt_pk_bf16_f32 v84, v76, v77
    v_exp_f32 v79, v115
    v_mfma_f32_32x32x16_bf16 v[136:151], v[60:63], v[80:83], v[136:151]
    ds_read_b128 v[60:63], v4 offset:6080
    v_exp_f32 v76, v116
    v_cvt_pk_bf16_f32 v85, v78, v79
    v_exp_f32 v77, v117
    v_exp_f32 v78, v118
    v_cvt_pk_bf16_f32 v86, v76, v77
    v_exp_f32 v79, v119
    v_mfma_f32_32x32x16_bf16 v[104:119], v[48:51], v[28:31], v[168:183]
    v_exp_f32 v76, v88
    v_cvt_pk_bf16_f32 v87, v78, v79
    v_exp_f32 v77, v89
    v_exp_f32 v78, v90
    v_cvt_pk_bf16_f32 v80, v76, v77
    v_exp_f32 v79, v91
    v_mfma_f32_32x32x8_bf16 v[104:119], v[74:75], v[40:41], v[104:119]
    v_exp_f32 v76, v92
    v_cvt_pk_bf16_f32 v81, v78, v79
    v_exp_f32 v77, v93
    v_exp_f32 v78, v94
    v_cvt_pk_bf16_f32 v82, v76, v77
    v_exp_f32 v79, v95
    v_mfma_f32_32x32x16_bf16 v[136:151], v[68:71], v[84:87], v[136:151]
    v_exp_f32 v76, v96
    v_cvt_pk_bf16_f32 v83, v78, v79
    v_exp_f32 v77, v97
    v_exp_f32 v78, v98
    v_cvt_pk_bf16_f32 v84, v76, v77
    v_exp_f32 v79, v99
    v_mfma_f32_32x32x16_bf16 v[120:135], v[56:59], v[80:83], v[120:135]
    s_waitcnt lgkmcnt(0)
    v_exp_f32 v76, v100
    v_cvt_pk_bf16_f32 v85, v78, v79
    v_exp_f32 v77, v101
    v_exp_f32 v78, v102
    v_cvt_pk_bf16_f32 v86, v76, v77
    v_exp_f32 v79, v103
    v_mfma_f32_32x32x16_bf16 v[88:103], v[52:55], v[24:27], v[152:167]
    ds_read_b128 v[48:51], v2 offset:6144
    v_exp_f32 v76, v104
    v_cvt_pk_bf16_f32 v87, v78, v79
    v_exp_f32 v77, v105
    v_exp_f32 v78, v106
    v_cvt_pk_bf16_f32 v80, v76, v77
    v_exp_f32 v79, v107
    v_mfma_f32_32x32x8_bf16 v[88:103], v[74:75], v[34:35], v[88:103]
    v_exp_f32 v76, v108
    v_cvt_pk_bf16_f32 v81, v78, v79
    v_exp_f32 v77, v109
    v_exp_f32 v78, v110
    v_cvt_pk_bf16_f32 v82, v76, v77
    v_exp_f32 v79, v111
    v_mfma_f32_32x32x16_bf16 v[120:135], v[64:67], v[84:87], v[120:135]
    ds_read_b128 v[68:71], v5 offset:6080
    v_exp_f32 v76, v112
    v_cvt_pk_bf16_f32 v83, v78, v79
    v_exp_f32 v77, v113
    v_exp_f32 v78, v114
    v_cvt_pk_bf16_f32 v84, v76, v77
    v_exp_f32 v79, v115
    v_mfma_f32_32x32x16_bf16 v[136:151], v[56:59], v[80:83], v[136:151]
    ds_read_b128 v[56:59], v4 offset:7296
    v_exp_f32 v76, v116
    v_cvt_pk_bf16_f32 v85, v78, v79
    v_exp_f32 v77, v117
    v_exp_f32 v78, v118
    v_cvt_pk_bf16_f32 v86, v76, v77
    v_exp_f32 v79, v119
    v_mfma_f32_32x32x16_bf16 v[104:119], v[52:55], v[28:31], v[168:183]
    v_exp_f32 v76, v88
    v_cvt_pk_bf16_f32 v87, v78, v79
    v_exp_f32 v77, v89
    v_exp_f32 v78, v90
    v_cvt_pk_bf16_f32 v80, v76, v77
    v_exp_f32 v79, v91
    v_mfma_f32_32x32x8_bf16 v[104:119], v[74:75], v[42:43], v[104:119]
    v_exp_f32 v76, v92
    v_cvt_pk_bf16_f32 v81, v78, v79
    v_exp_f32 v77, v93
    v_exp_f32 v78, v94
    v_cvt_pk_bf16_f32 v82, v76, v77
    v_exp_f32 v79, v95
    v_mfma_f32_32x32x16_bf16 v[136:151], v[64:67], v[84:87], v[136:151]
    v_exp_f32 v76, v96
    v_cvt_pk_bf16_f32 v83, v78, v79
    v_exp_f32 v77, v97
    v_exp_f32 v78, v98
    v_cvt_pk_bf16_f32 v84, v76, v77
    v_exp_f32 v79, v99
    v_mfma_f32_32x32x16_bf16 v[120:135], v[60:63], v[80:83], v[120:135]
    s_waitcnt lgkmcnt(0)
    v_exp_f32 v76, v100
    v_cvt_pk_bf16_f32 v85, v78, v79
    v_exp_f32 v77, v101
    v_exp_f32 v78, v102
    v_cvt_pk_bf16_f32 v86, v76, v77
    v_exp_f32 v79, v103
    v_mfma_f32_32x32x16_bf16 v[88:103], v[48:51], v[24:27], v[152:167]
    ds_read_b128 v[52:55], v2 offset:7168
    v_exp_f32 v76, v104
    v_cvt_pk_bf16_f32 v87, v78, v79
    v_exp_f32 v77, v105
    v_exp_f32 v78, v106
    v_cvt_pk_bf16_f32 v80, v76, v77
    v_exp_f32 v79, v107
    v_mfma_f32_32x32x8_bf16 v[88:103], v[74:75], v[36:37], v[88:103]
    ds_read_b64 v[72:73], v3 offset:18944
    v_exp_f32 v76, v108
    v_cvt_pk_bf16_f32 v81, v78, v79
    v_exp_f32 v77, v109
    v_exp_f32 v78, v110
    v_cvt_pk_bf16_f32 v82, v76, v77
    v_exp_f32 v79, v111
    v_mfma_f32_32x32x16_bf16 v[120:135], v[68:71], v[84:87], v[120:135]
    ds_read_b128 v[64:67], v5 offset:7296
    v_exp_f32 v76, v112
    v_cvt_pk_bf16_f32 v83, v78, v79
    v_exp_f32 v77, v113
    v_exp_f32 v78, v114
    v_cvt_pk_bf16_f32 v84, v76, v77
    v_exp_f32 v79, v115
    v_mfma_f32_32x32x16_bf16 v[136:151], v[60:63], v[80:83], v[136:151]
    ds_read_b128 v[60:63], v4 offset:8512
    v_exp_f32 v76, v116
    v_cvt_pk_bf16_f32 v85, v78, v79
    v_exp_f32 v77, v117
    v_exp_f32 v78, v118
    v_cvt_pk_bf16_f32 v86, v76, v77
    v_exp_f32 v79, v119
    v_mfma_f32_32x32x16_bf16 v[104:119], v[48:51], v[28:31], v[168:183]
    v_exp_f32 v76, v88
    v_cvt_pk_bf16_f32 v87, v78, v79
    v_exp_f32 v77, v89
    v_exp_f32 v78, v90
    v_cvt_pk_bf16_f32 v80, v76, v77
    v_exp_f32 v79, v91
    v_mfma_f32_32x32x8_bf16 v[104:119], v[74:75], v[44:45], v[104:119]
    v_exp_f32 v76, v92
    v_cvt_pk_bf16_f32 v81, v78, v79
    v_exp_f32 v77, v93
    v_exp_f32 v78, v94
    v_cvt_pk_bf16_f32 v82, v76, v77
    v_exp_f32 v79, v95
    v_mfma_f32_32x32x16_bf16 v[136:151], v[68:71], v[84:87], v[136:151]
    v_exp_f32 v76, v96
    v_cvt_pk_bf16_f32 v83, v78, v79
    v_exp_f32 v77, v97
    v_exp_f32 v78, v98
    v_cvt_pk_bf16_f32 v84, v76, v77
    v_exp_f32 v79, v99
    v_mfma_f32_32x32x16_bf16 v[120:135], v[56:59], v[80:83], v[120:135]
    s_waitcnt lgkmcnt(0)
    v_exp_f32 v76, v100
    v_cvt_pk_bf16_f32 v85, v78, v79
    v_exp_f32 v77, v101
    v_exp_f32 v78, v102
    v_cvt_pk_bf16_f32 v86, v76, v77
    v_exp_f32 v79, v103
    v_mfma_f32_32x32x16_bf16 v[88:103], v[52:55], v[24:27], v[152:167]
    ds_read_b128 v[48:51], v2 offset:18944
    v_exp_f32 v76, v104
    v_cvt_pk_bf16_f32 v87, v78, v79
    v_exp_f32 v77, v105
    v_exp_f32 v78, v106
    v_cvt_pk_bf16_f32 v80, v76, v77
    v_exp_f32 v79, v107
    v_mfma_f32_32x32x8_bf16 v[88:103], v[74:75], v[38:39], v[88:103]
    v_exp_f32 v76, v108
    v_cvt_pk_bf16_f32 v81, v78, v79
    v_exp_f32 v77, v109
    v_exp_f32 v78, v110
    v_cvt_pk_bf16_f32 v82, v76, v77
    v_exp_f32 v79, v111
    v_mfma_f32_32x32x16_bf16 v[120:135], v[64:67], v[84:87], v[120:135]
    ds_read_b128 v[68:71], v5 offset:8512
    v_exp_f32 v76, v112
    v_cvt_pk_bf16_f32 v83, v78, v79
    v_exp_f32 v77, v113
    v_exp_f32 v78, v114
    v_cvt_pk_bf16_f32 v84, v76, v77
    v_exp_f32 v79, v115
    v_mfma_f32_32x32x16_bf16 v[136:151], v[56:59], v[80:83], v[136:151]
    ds_read_b128 v[56:59], v4 offset:18944
    v_exp_f32 v76, v116
    v_cvt_pk_bf16_f32 v85, v78, v79
    v_exp_f32 v77, v117
    v_exp_f32 v78, v118
    v_cvt_pk_bf16_f32 v86, v76, v77
    v_exp_f32 v79, v119
    v_mfma_f32_32x32x16_bf16 v[104:119], v[52:55], v[28:31], v[168:183]
    s_add_u32 s67, s67, 1
    v_exp_f32 v76, v88
    v_cvt_pk_bf16_f32 v87, v78, v79
    v_exp_f32 v77, v89
    v_exp_f32 v78, v90
    v_cvt_pk_bf16_f32 v80, v76, v77
    v_exp_f32 v79, v91
    v_mfma_f32_32x32x8_bf16 v[104:119], v[74:75], v[46:47], v[104:119]
    s_cmp_lt_u32 s67, 8
    v_exp_f32 v76, v92
    v_cvt_pk_bf16_f32 v81, v78, v79
    v_exp_f32 v77, v93
    v_exp_f32 v78, v94
    v_cvt_pk_bf16_f32 v82, v76, v77
    v_exp_f32 v79, v95
    v_mfma_f32_32x32x16_bf16 v[136:151], v[64:67], v[84:87], v[136:151]
    v_exp_f32 v76, v96
    v_cvt_pk_bf16_f32 v83, v78, v79
    v_exp_f32 v77, v97
    v_exp_f32 v78, v98
    v_cvt_pk_bf16_f32 v84, v76, v77
    v_exp_f32 v79, v99
    v_mfma_f32_32x32x16_bf16 v[120:135], v[60:63], v[80:83], v[120:135]
    s_waitcnt lgkmcnt(0)
    v_exp_f32 v76, v100
    v_cvt_pk_bf16_f32 v85, v78, v79
    v_exp_f32 v77, v101
    v_exp_f32 v78, v102
    v_cvt_pk_bf16_f32 v86, v76, v77
    v_exp_f32 v79, v103
    v_mfma_f32_32x32x16_bf16 v[88:103], v[48:51], v[24:27], v[152:167]
    ds_read_b128 v[52:55], v2 offset:19968
    v_exp_f32 v76, v104
    v_cvt_pk_bf16_f32 v87, v78, v79
    v_exp_f32 v77, v105
    v_exp_f32 v78, v106
    v_cvt_pk_bf16_f32 v80, v76, v77
    v_exp_f32 v79, v107
    v_mfma_f32_32x32x8_bf16 v[88:103], v[72:73], v[32:33], v[88:103]
    v_exp_f32 v76, v108
    v_cvt_pk_bf16_f32 v81, v78, v79
    v_exp_f32 v77, v109
    v_exp_f32 v78, v110
    v_cvt_pk_bf16_f32 v82, v76, v77
    v_exp_f32 v79, v111
    v_mfma_f32_32x32x16_bf16 v[120:135], v[68:71], v[84:87], v[120:135]
    ds_read_b128 v[64:67], v5 offset:18944
    v_exp_f32 v76, v112
    v_cvt_pk_bf16_f32 v83, v78, v79
    v_exp_f32 v77, v113
    v_exp_f32 v78, v114
    v_cvt_pk_bf16_f32 v84, v76, v77
    v_exp_f32 v79, v115
    v_mfma_f32_32x32x16_bf16 v[136:151], v[60:63], v[80:83], v[136:151]
    ds_read_b128 v[60:63], v4 offset:20160
    v_exp_f32 v76, v116
    v_cvt_pk_bf16_f32 v85, v78, v79
    v_exp_f32 v77, v117
    v_exp_f32 v78, v118
    v_cvt_pk_bf16_f32 v86, v76, v77
    v_exp_f32 v79, v119
    v_add_u32 v2, 18944, v2
    v_add_u32 v3, 18944, v3
    v_add_u32 v4, 18944, v4
    v_add_u32 v5, 18944, v5
    s_cbranch_scc1 L_aloop_91
    s_branch L_aepi_58
L_hredo_79:
    s_and_b32 s66, s3, 3
    s_lshl_b32 s66, s66, 12
    s_add_u32 s66, s66, 0
    s_mul_i32 s67, s62, 151552
    s_add_u32 s67, s67, s66
    s_add_u32 s67, s67, 0
    s_add_u32 m0, s66, 0
    s_nop 0
    buffer_load_dwordx4 v225, s[16:19], s67 offen sc1 lds
    buffer_load_dwordx4 v225, s[16:19], s67 offen offset:1024 sc1 lds
    buffer_load_dwordx4 v225, s[16:19], s67 offen offset:2048 sc1 lds
    buffer_load_dwordx4 v225, s[16:19], s67 offen offset:3072 sc1 lds
    s_add_u32 m0, s66, 16384
    s_add_u32 s67, s67, 16384
    buffer_load_dwordx4 v225, s[16:19], s67 offen sc1 lds
    buffer_load_dwordx4 v225, s[16:19], s67 offen offset:1024 sc1 lds
    buffer_load_dwordx4 v225, s[16:19], s67 offen offset:2048 sc1 lds
    buffer_load_dwordx4 v225, s[16:19], s67 offen offset:3072 sc1 lds
    s_add_u32 m0, s66, 32768
    s_add_u32 s67, s67, 16384
    buffer_load_dwordx4 v225, s[16:19], s67 offen sc1 lds
    buffer_load_dwordx4 v225, s[16:19], s67 offen offset:1024 sc1 lds
    buffer_load_dwordx4 v225, s[16:19], s67 offen offset:2048 sc1 lds
    buffer_load_dwordx4 v225, s[16:19], s67 offen offset:3072 sc1 lds
    s_add_u32 m0, s66, 49152
    s_add_u32 s67, s67, 16384
    buffer_load_dwordx4 v225, s[16:19], s67 offen sc1 lds
    buffer_load_dwordx4 v225, s[16:19], s67 offen offset:1024 sc1 lds
    buffer_load_dwordx4 v225, s[16:19], s67 offen offset:2048 sc1 lds
    buffer_load_dwordx4 v225, s[16:19], s67 offen offset:3072 sc1 lds
    s_add_u32 m0, s66, 65536
    s_add_u32 s67, s67, 16384
    buffer_load_dwordx4 v225, s[16:19], s67 offen sc1 lds
    buffer_load_dwordx4 v225, s[16:19], s67 offen offset:1024 sc1 lds
    buffer_load_dwordx4 v225, s[16:19], s67 offen offset:2048 sc1 lds
    buffer_load_dwordx4 v225, s[16:19], s67 offen offset:3072 sc1 lds
    s_add_u32 m0, s66, 81920
    s_add_u32 s67, s67, 16384
    buffer_load_dwordx4 v225, s[16:19], s67 offen sc1 lds
    buffer_load_dwordx4 v225, s[16:19], s67 offen offset:1024 sc1 lds
    buffer_load_dwordx4 v225, s[16:19], s67 offen offset:2048 sc1 lds
    buffer_load_dwordx4 v225, s[16:19], s67 offen offset:3072 sc1 lds
    s_add_u32 m0, s66, 98304
    s_add_u32 s67, s67, 16384
    buffer_load_dwordx4 v225, s[16:19], s67 offen sc1 lds
    buffer_load_dwordx4 v225, s[16:19], s67 offen offset:1024 sc1 lds
    buffer_load_dwordx4 v225, s[16:19], s67 offen offset:2048 sc1 lds
    buffer_load_dwordx4 v225, s[16:19], s67 offen offset:3072 sc1 lds
    s_add_u32 m0, s66, 114688
    s_add_u32 s67, s67, 16384
    buffer_load_dwordx4 v225, s[16:19], s67 offen sc1 lds
    buffer_load_dwordx4 v225, s[16:19], s67 offen offset:1024 sc1 lds
    buffer_load_dwordx4 v225, s[16:19], s67 offen offset:2048 sc1 lds
    buffer_load_dwordx4 v225, s[16:19], s67 offen offset:3072 sc1 lds
    s_add_u32 m0, s66, 131072
    s_add_u32 s67, s67, 16384
    buffer_load_dwordx4 v225, s[16:19], s67 offen sc1 lds
    buffer_load_dwordx4 v225, s[16:19], s67 offen offset:1024 sc1 lds
    buffer_load_dwordx4 v225, s[16:19], s67 offen offset:2048 sc1 lds
    buffer_load_dwordx4 v225, s[16:19], s67 offen offset:3072 sc1 lds
    s_cmp_ge_u32 s3, 5
    s_cbranch_scc1 L_kvlast_94
    s_add_u32 m0, s66, 147456
    s_add_u32 s67, s67, 16384
    buffer_load_dwordx4 v225, s[16:19], s67 offen sc1 lds
    buffer_load_dwordx4 v225, s[16:19], s67 offen offset:1024 sc1 lds
    buffer_load_dwordx4 v225, s[16:19], s67 offen offset:2048 sc1 lds
    buffer_load_dwordx4 v225, s[16:19], s67 offen offset:3072 sc1 lds
L_kvlast_94:
    v_add_u32 v2, 0, v1
    v_mul_u32_u24 v3, 171, v2
    v_lshrrev_b32 v3, 11, v3
    v_mul_u32_u24 v4, 12, v3
    v_sub_u32 v2, v2, v4
    v_lshrrev_b32 v4, 3, v3
    v_lshlrev_b32 v5, 1, v4
    v_xor_b32 v2, v2, v5
    v_lshlrev_b32 v2, 4, v2
    v_and_b32 v5, 3, v3
    v_bfe_u32 v6, v3, 2, 1
    v_lshl_add_u32 v5, v6, 3, v5
    v_lshl_add_u32 v5, v4, 2, v5
    v_mul_u32_u24 v5, 1152, v5
    v_add_u32 v8, v5, v2
    v_lshrrev_b32 v5, 1, v3
    v_mul_u32_u24 v5, 18, v5
    v_and_b32 v6, 1, v3
    v_add3_u32 v5, v5, v6, 16
    v_bfe_u32 v6, v3, 1, 1
    v_lshlrev_b32 v6, 4, v6
    v_sub_u32 v5, v5, v6
    v_mul_u32_u24 v5, 1152, v5
    v_add_u32 v11, v5, v2
    v_add_u32 v2, 64, v1
    v_mul_u32_u24 v3, 171, v2
    v_lshrrev_b32 v3, 11, v3
    v_mul_u32_u24 v4, 12, v3
    v_sub_u32 v2, v2, v4
    v_lshrrev_b32 v4, 3, v3
    v_lshlrev_b32 v5, 1, v4
    v_xor_b32 v2, v2, v5
    v_lshlrev_b32 v2, 4, v2
    v_and_b32 v5, 3, v3
    v_bfe_u32 v6, v3, 2, 1
    v_lshl_add_u32 v5, v6, 3, v5
    v_lshl_add_u32 v5, v4, 2, v5
    v_mul_u32_u24 v5, 1152, v5
    v_add_u32 v9, v5, v2
    v_lshrrev_b32 v5, 1, v3
    v_mul_u32_u24 v5, 18, v5
    v_and_b32 v6, 1, v3
    v_add3_u32 v5, v5, v6, 16
    v_bfe_u32 v6, v3, 1, 1
    v_lshlrev_b32 v6, 4, v6
    v_sub_u32 v5, v5, v6
    v_mul_u32_u24 v5, 1152, v5
    v_add_u32 v12, v5, v2
    v_add_u32 v2, 128, v1
    v_mul_u32_u24 v3, 171, v2
    v_lshrrev_b32 v3, 11, v3
    v_mul_u32_u24 v4, 12, v3
    v_sub_u32 v2, v2, v4
    v_lshrrev_b32 v4, 3, v3
    v_lshlrev_b32 v5, 1, v4
    v_xor_b32 v2, v2, v5
    v_lshlrev_b32 v2, 4, v2
    v_and_b32 v5, 3, v3
    v_bfe_u32 v6, v3, 2, 1
    v_lshl_add_u32 v5, v6, 3, v5
    v_lshl_add_u32 v5, v4, 2, v5
    v_mul_u32_u24 v5, 1152, v5
    v_add_u32 v10, v5, v2
    v_lshrrev_b32 v5, 1, v3
    v_mul_u32_u24 v5, 18, v5
    v_and_b32 v6, 1, v3
    v_add3_u32 v5, v5, v6, 16
    v_bfe_u32 v6, v3, 1, 1
    v_lshlrev_b32 v6, 4, v6
    v_sub_u32 v5, v5, v6
    v_mul_u32_u24 v5, 1152, v5
    v_add_u32 v13, v5, v2
    s_waitcnt vmcnt(0)
    s_barrier
    s_barrier
    s_cmp_ge_u32 s61, 24
    s_cbranch_scc1 L_nowo2_92
    s_and_b32 s67, s3, 3
    s_mul_i32 s64, s91, 192
    s_mul_i32 s65, s67, 20736
    s_add_u32 s65, s65, s64
    s_and_b32 s66, s67, 1
    s_mul_i32 s66, s66, 2304
    s_add_u32 s65, s65, s66
    s_mul_i32 s66, s67, 3072
    s_add_u32 m0, s66, 0
    s_nop 0
    buffer_load_dwordx4 v8, s[28:31], s65 offen lds
    s_add_u32 m0, s66, 1024
    s_nop 0
    buffer_load_dwordx4 v9, s[28:31], s65 offen lds
    s_add_u32 m0, s66, 2048
    s_nop 0
    buffer_load_dwordx4 v10, s[28:31], s65 offen lds
    s_add_u32 m0, s66, 12288
    s_add_u32 s65, s65, 82944
    buffer_load_dwordx4 v8, s[28:31], s65 offen lds
    s_add_u32 m0, s66, 13312
    s_nop 0
    buffer_load_dwordx4 v9, s[28:31], s65 offen lds
    s_add_u32 m0, s66, 14336
    s_nop 0
    buffer_load_dwordx4 v10, s[28:31], s65 offen lds
    s_add_u32 m0, s66, 24576
    s_add_u32 s65, s65, 82944
    buffer_load_dwordx4 v8, s[28:31], s65 offen lds
    s_add_u32 m0, s66, 25600
    s_nop 0
    buffer_load_dwordx4 v9, s[28:31], s65 offen lds
    s_add_u32 m0, s66, 26624
    s_nop 0
    buffer_load_dwordx4 v10, s[28:31], s65 offen lds
    s_add_u32 m0, s66, 36864
    s_add_u32 s65, s65, 82944
    buffer_load_dwordx4 v8, s[28:31], s65 offen lds
    s_add_u32 m0, s66, 37888
    s_nop 0
    buffer_load_dwordx4 v9, s[28:31], s65 offen lds
    s_add_u32 m0, s66, 38912
    s_nop 0
    buffer_load_dwordx4 v10, s[28:31], s65 offen lds
    s_add_u32 m0, s66, 49152
    s_add_u32 s65, s65, 82944
    buffer_load_dwordx4 v8, s[28:31], s65 offen lds
    s_add_u32 m0, s66, 50176
    s_nop 0
    buffer_load_dwordx4 v9, s[28:31], s65 offen lds
    s_add_u32 m0, s66, 51200
    s_nop 0
    buffer_load_dwordx4 v10, s[28:31], s65 offen lds
    s_add_u32 m0, s66, 61440
    s_add_u32 s65, s65, 82944
    buffer_load_dwordx4 v8, s[28:31], s65 offen lds
    s_add_u32 m0, s66, 62464
    s_nop 0
    buffer_load_dwordx4 v9, s[28:31], s65 offen lds
    s_add_u32 m0, s66, 63488
    s_nop 0
    buffer_load_dwordx4 v10, s[28:31], s65 offen lds
    s_add_u32 m0, s66, 73728
    s_add_u32 s65, s65, 82944
    buffer_load_dwordx4 v8, s[28:31], s65 offen lds
    s_add_u32 m0, s66, 74752
    s_nop 0
    buffer_load_dwordx4 v9, s[28:31], s65 offen lds
    s_add_u32 m0, s66, 75776
    s_nop 0
    buffer_load_dwordx4 v10, s[28:31], s65 offen lds
    s_add_u32 m0, s66, 86016
    s_add_u32 s65, s65, 82944
    buffer_load_dwordx4 v8, s[28:31], s65 offen lds
    s_add_u32 m0, s66, 87040
    s_nop 0
    buffer_load_dwordx4 v9, s[28:31], s65 offen lds
    s_add_u32 m0, s66, 88064
    s_nop 0
    buffer_load_dwordx4 v10, s[28:31], s65 offen lds
    s_mul_i32 s65, s67, 165888
    s_add_u32 s65, s65, s64
    s_add_u32 m0, s66, 98304
    s_nop 0
    buffer_load_dwordx4 v11, s[28:31], s65 offen lds
    s_add_u32 m0, s66, 99328
    s_nop 0
    buffer_load_dwordx4 v12, s[28:31], s65 offen lds
    s_add_u32 m0, s66, 100352
    s_nop 0
    buffer_load_dwordx4 v13, s[28:31], s65 offen lds
L_nowo2_92:
    s_waitcnt vmcnt(0)
    s_barrier
    s_cmp_ge_u32 s61, 24
    s_cbranch_scc1 L_hz_80
    s_branch L_hz_80
L_code_end:
.section .rodata,"a"
.p2align 6
.amdhsa_kernel concat_heads__ssm_conv_s4__mha_block__prompt_kernel
  .amdhsa_next_free_vgpr 256
  .amdhsa_next_free_sgpr 102
  .amdhsa_accum_offset 256
  .amdhsa_group_segment_fixed_size 0
  .amdhsa_kernarg_size 120
  .amdhsa_user_sgpr_count 2
  .amdhsa_user_sgpr_kernarg_segment_ptr 1
  .amdhsa_system_sgpr_workgroup_id_x 1
.end_amdhsa_kernel
```
